```python
import torch

def _softmax(x, axis=-1):
    return torch.softmax(x, dim=axis)
def _gelu(x):
    return torch.nn.functional.gelu(x, approximate="tanh")
def _silu(x):
    return torch.nn.functional.silu(x)
def _sigmoid(x):
    return torch.sigmoid(x)
def _layernorm(x, axis=-1, eps=1e-5):
    m = x.mean(dim=axis, keepdim=True)
    v = x.var(dim=axis, keepdim=True, unbiased=False)
    return (x - m) / torch.sqrt(v + eps)
def _scatter_add(tgt, idx, src, axis=0):
    return tgt.clone().index_add_(axis, idx, src)
def _segment_sum(src, seg, n):
    out = torch.zeros((n,) + src.shape[1:], dtype=src.dtype)
    return out.index_add_(0, seg, src)
def _pad(x, pw):
    flat = tuple(v for pair in reversed(pw) for v in pair)
    return torch.nn.functional.pad(x, flat)

kernel_name = 'standalone__edge_featured_mpnn_gatedgcn__graph'

def setup_inputs():

    _w = (lambda a: (lambda t: t.to(torch.bfloat16) if t.is_floating_point() else t)(torch.as_tensor(a)))
    N, deg, D, De = 25000, 32, 64, max(0, 1)
    E = N * deg
    return {
        "x": _w((lambda *s: torch.randn(*s, dtype=torch.bfloat16) * 0.8)(N, D)),
        "e_attr": _w((lambda *s: torch.randn(*s, dtype=torch.bfloat16) * 0.8)(E, De)),
        "src": _w((lambda lo, hi, *s: torch.randint(lo, hi, s))(0, N, E).to(torch.int64)),
        "dst": _w((lambda lo, hi, *s: torch.randint(lo, hi, s))(0, N, E).to(torch.int64)),
        "w_a": _w((lambda *s: torch.randn(*s, dtype=torch.bfloat16) * 0.8)(D, D)),
        "w_b": _w((lambda *s: torch.randn(*s, dtype=torch.bfloat16) * 0.8)(D, D)),
        "w_c": _w((lambda *s: torch.randn(*s, dtype=torch.bfloat16) * 0.8)(De, D)),
        "w_u": _w((lambda *s: torch.randn(*s, dtype=torch.bfloat16) * 0.05)(D, D)),
        "w_v": _w((lambda *s: torch.randn(*s, dtype=torch.bfloat16) * 0.05)(D, D)),
    }

def reference(x, e_attr, src, dst, w_a, w_b, w_c, w_u, w_v):
    N, D = x.shape
    hv = x @ w_v
    g = x[dst] @ w_a + x[src] @ w_b + e_attr @ w_c
    eta = _sigmoid(g)
    denom = _segment_sum(eta, dst, N) + 1e-6
    eta_n = eta / denom[dst]
    agg = _segment_sum(eta_n * hv[src], dst, N)
    z = x @ w_u + agg
    relu_z = torch.where(z > 0, z, 0 * z)
    return x + relu_z
```

```asm
; @launch grid=(256,1,1) block=(1024,1,1) lds=155072
.amdgcn_target "amdgcn-amd-amdhsa--gfx950"
.text
.globl standalone__edge_featured_mpnn_gatedgcn__graph_kernel
.p2align 8
.type standalone__edge_featured_mpnn_gatedgcn__graph_kernel,@function
standalone__edge_featured_mpnn_gatedgcn__graph_kernel:
    s_cmp_ge_u32 s2, 256
    s_cbranch_scc1 K_END
    s_load_dwordx16 s[76:91], s[0:1], 0
    s_load_dwordx8 s[92:99], s[0:1], 64
    s_and_b32 s31, s2, 1
    s_bfe_u32 s60, s2, 0x20001
    s_lshr_b32 s61, s2, 3
    s_lshl_b32 s30, s60, 5
    s_add_u32 s30, s30, s61
    s_mul_i32 s59, s30, 196
    v_readfirstlane_b32 s32, v0
    s_lshr_b32 s32, s32, 6
    v_and_b32 v1, 63, v0
    v_and_b32 v26, 7, v1
    v_lshrrev_b32 v27, 4, v1
    v_xor_b32 v27, v26, v27
    v_lshlrev_b32 v27, 4, v27
    v_lshrrev_b32 v28, 3, v1
    v_lshl_add_u32 v24, v28, 7, v27
    v_xor_b32 v25, 64, v24
    v_lshlrev_b32 v29, 4, v1
    s_lshl_b32 s66, s31, 6
    s_lshl_b32 s67, s59, 7
    s_sub_u32 s69, s32, 7
    s_mov_b32 s68, 4853760
    s_cmp_ge_u32 s32, 7
    s_cbranch_scc1 K_L1
    s_mul_i32 s62, s31, 12
    s_lshl_b32 s63, s32, 1
    s_add_u32 s62, s62, s63
    s_cmp_eq_u32 s32, 6
    s_cselect_b32 s62, 24, s62
    s_lshl_b32 s62, s62, 10
    s_add_u32 m0, s62, 62080
    s_add_u32 s62, s62, s67
    s_lshl_b32 s63, s32, 10
    s_memrealtime s[56:57]
    s_waitcnt lgkmcnt(0)
    s_bfe_u32 s44, s56, 262154
    s_or_b32 s74, s2, s32
    s_cmp_lg_u32 s74, 0
    s_cbranch_scc1 K_NEP
    s_mov_b32 s20, s96
    s_mov_b32 s21, s97
    s_mov_b32 s22, 256
    s_mov_b32 s23, 0x20000
    v_lshlrev_b32 v34, 6, v1
    s_lshl_b32 s74, s57, 20
    s_lshl_b32 s75, s44, 4
    s_or_b32 s74, s74, s75
    s_or_b32 s74, s74, 1
    v_mov_b32 v32, s74
    v_mov_b32 v33, s56
    s_mov_b64 exec, 15
    buffer_store_dwordx2 v[32:33], v34, s[20:23], 0 offen sc1
    s_mov_b64 exec, -1
K_NEP:
    s_mov_b32 s16, s76
    s_mov_b32 s17, s77
    s_mov_b32 s18, 3200000
    s_mov_b32 s19, 0x20000
    s_mov_b32 s20, s86
    s_mov_b32 s21, s87
    s_mov_b32 s22, 8192
    s_mov_b32 s23, 0x20000
    s_mov_b32 s24, s92
    s_mov_b32 s25, s93
    s_mov_b32 s26, 8192
    s_mov_b32 s27, 0x20000
    buffer_load_dwordx4 v24, s[16:19], s62 offen lds
    s_cmp_eq_u32 s32, 6
    s_cbranch_scc1 K_L0
    buffer_load_dwordx4 v25, s[16:19], s62 offen offset:1024 lds
K_L0:
    s_add_u32 m0, s63, 7680
    s_nop 0
    buffer_load_dwordx4 v29, s[20:23], s63 offen lds
    s_add_u32 m0, s63, 15872
    s_cmp_eq_u32 s32, 6
    buffer_load_dwordx4 v29, s[24:27], s63 offen lds
    s_cbranch_scc0 K_L1
    buffer_load_dwordx4 v29, s[24:27], s63 offen offset:1024 lds
    s_add_u32 m0, s63, 7680
    s_nop 0
    buffer_load_dwordx4 v29, s[20:23], s63 offen offset:1024 lds
K_L1:
    v_mul_u32_u24 v30, 296, v0
    v_add_u32 v30, 95872, v30
    v_cmp_gt_u32 vcc, 200, v0
    v_mov_b32 v31, 0x40000000
    s_nop 0
    v_cndmask_b32 v30, v31, v30, vcc
    v_cmp_gt_u32 vcc, 256, v0
    v_subrev_u32 v32, 384, v0
    s_nop 0
    v_cndmask_b32 v30, 0, v30, vcc
    v_cmp_gt_u32 vcc, 256, v32
    v_mov_b32 v31, 196
    s_nop 0
    v_cndmask_b32 v30, v30, v31, vcc
    v_lshlrev_b32 v31, 2, v0
    ds_write_b32 v31, v30
    v_subrev_u32 v34, 448, v0
    v_lshlrev_b32 v32, 4, v34
    v_lshlrev_b32 v33, 3, v34
    s_mul_i32 s70, s2, 12512
    s_add_u32 s71, s70, 6256
    s_lshr_b32 s72, s70, 1
    s_lshr_b32 s73, s71, 1
    s_waitcnt lgkmcnt(0)
    s_mov_b32 s20, s82
    s_mov_b32 s21, s83
    s_mov_b32 s22, 3200000
    s_mov_b32 s23, 0x20000
    s_mov_b32 s24, s80
    s_mov_b32 s25, s81
    s_mov_b32 s26, 3200000
    s_mov_b32 s27, 0x20000
    s_mov_b32 s4, s78
    s_mov_b32 s5, s79
    s_mov_b32 s6, 1600000
    s_mov_b32 s7, 0x20000
    s_mov_b32 s16, s76
    s_mov_b32 s17, s77
    s_mov_b32 s18, 3200000
    s_mov_b32 s19, 0x20000
    s_mov_b32 s12, s88
    s_mov_b32 s13, s89
    s_mov_b32 s14, 128
    s_mov_b32 s15, 0x20000
    v_lshlrev_b32 v27, 3, v26
    v_cmp_gt_u32 vcc, 391, v34
    v_mov_b32 v36, 25088
    v_mov_b32 v37, 25088
    v_mov_b32 v38, 25088
    v_mov_b32 v39, 25088
    v_lshlrev_b32 v30, 4, v0
    v_add_u32 v30, 95872, v30
    s_barrier
    buffer_load_dwordx2 v[22:23], v27, s[12:15], s66 offen
    s_cmp_ge_u32 s69, 7
    s_cbranch_scc1 K_NE0
    s_mov_b64 exec, vcc
    buffer_load_dwordx4 v[64:67], v32, s[20:23], s70 offen nt
    buffer_load_dwordx4 v[68:71], v32, s[20:23], s71 offen nt
    s_mov_b64 exec, -1
    v_mov_b32 v40, -1
    v_mov_b32 v41, -1
    ds_write_b64 v33, v[40:41] offset:4096
K_NE0:
    ds_write_b128 v30, v[36:39] offset:14336
    ds_write_b128 v30, v[36:39] offset:30720
    s_cbranch_scc1 K_NE
    s_mov_b64 exec, vcc
    buffer_load_dwordx4 v[72:75], v32, s[24:27], s70 offen nt
    buffer_load_dwordx4 v[76:79], v32, s[24:27], s71 offen nt
    buffer_load_dwordx2 v[80:81], v33, s[4:7], s72 offen nt
    buffer_load_dwordx2 v[82:83], v33, s[4:7], s73 offen nt
    s_mov_b64 exec, -1
K_NE:
    ds_write_b128 v30, v[36:39] offset:47104
    s_mov_b32 s4, s98
    s_mov_b32 s5, s99
    s_mov_b32 s6, 12845056
    s_mov_b32 s7, 0x20000
    s_mov_b32 s12, s94
    s_mov_b32 s13, s95
    s_mov_b32 s14, 3200000
    s_mov_b32 s15, 0x20000
    s_mul_i32 s62, s31, 3276800
    s_add_u32 s62, s62, 6291456
    s_mov_b32 s10, 25089
    s_mov_b32 s11, 0x20000
    s_mul_i32 s58, s61, 100352
    s_add_u32 s58, s58, s62
    s_add_u32 s63, s67, s66
    v_add_u32 v6, s63, v27
    v_lshlrev_b32 v45, 4, v26
    v_mov_b32 v47, v45
    v_add_u32 v5, 7680, v45
    v_lshlrev_b32 v4, 2, v28
    s_mov_b32 s28, 0x27800000
    s_mov_b32 s29, 0x27800000
    s_mov_b32 s54, 0x4d8637bd
    s_mov_b32 s55, 0x4d8637bd
    s_mov_b32 s49, 0xffff0000
    v_mov_b32 v120, 1436
    v_mov_b32 v121, 1
    s_mov_b64 exec, 1
    ds_add_u32 v120, v121
    s_mov_b64 exec, -1
    s_cmp_ge_u32 s32, 14
    s_cbranch_scc1 K_HELP
    s_cmp_ge_u32 s32, 7
    s_cbranch_scc1 K_BIN
    s_mul_i32 s70, s31, 3
    s_lshr_b32 s71, s32, 1
    s_add_u32 s70, s70, s71
    s_and_b32 s71, s32, 1
    s_cmp_eq_u32 s32, 6
    s_cselect_b32 s70, 6, s70
    s_cselect_b32 s71, s31, s71
    s_lshl_b32 s72, s70, 12
    s_mul_i32 s73, s71, 3276800
    s_add_u32 s73, s73, s67
    s_add_u32 s75, s73, 6291456
    s_mov_b32 s26, 25088
    s_mov_b32 s27, 0x20000
    v_and_b32 v28, 31, v1
    v_lshrrev_b32 v29, 5, v1
    v_bfe_u32 v30, v28, 1, 3
    v_xor_b32 v30, v30, v29
    v_lshlrev_b32 v30, 4, v30
    v_lshl_add_u32 v24, v28, 7, v30
    s_add_u32 s73, s72, 62080
    v_add_u32 v30, s73, v24
    v_bfe_u32 v25, v1, 2, 2
    v_lshl_add_u32 v25, v29, 3, v25
    v_lshlrev_b32 v34, 7, v25
    v_bfe_u32 v35, v1, 4, 1
    v_lshl_add_u32 v34, v35, 5, v34
    v_and_b32 v36, 3, v1
    v_lshl_add_u32 v34, v36, 3, v34
    s_lshl_b32 s73, s71, 6
    s_add_u32 s73, s73, 7680
    v_add_u32 v34, s73, v34
    v_and_b32 v32, 1, v1
    v_xor_b32 v32, 1, v32
    v_lshlrev_b32 v32, 15, v32
    v_lshlrev_b32 v33, 9, v29
    v_lshl_add_u32 v33, v28, 2, v33
    v_add_u32 v33, s72, v33
    s_mov_b32 s73, 0xbfb8aa3b
    s_mov_b32 s74, 0x07060302
    s_waitcnt vmcnt(1)
    v_mov_b32 v120, 1424
    v_mov_b32 v121, 1
    s_mov_b64 exec, 1
    ds_add_u32 v120, v121
    s_mov_b64 exec, -1
K_SPX:
    ds_read_b32 v122, v120
    s_waitcnt lgkmcnt(0)
    v_readfirstlane_b32 s60, v122
    s_cmp_lt_u32 s60, 7
    s_cbranch_scc1 K_SPX
    v_xor_b32 v31, 0, v30
    ds_read_b128 v[84:87], v31
    ds_read_b64_tr_b16 v[100:101], v34 offset:0
    ds_read_b64_tr_b16 v[102:103], v34 offset:512
    ds_read_b64_tr_b16 v[36:37], v34 offset:8192
    ds_read_b64_tr_b16 v[38:39], v34 offset:8704
    v_xor_b32 v31, 32, v30
    ds_read_b128 v[88:91], v31
    ds_read_b64_tr_b16 v[104:105], v34 offset:2048
    ds_read_b64_tr_b16 v[106:107], v34 offset:2560
    ds_read_b64_tr_b16 v[40:41], v34 offset:10240
    ds_read_b64_tr_b16 v[42:43], v34 offset:10752
    v_xor_b32 v31, 64, v30
    ds_read_b128 v[92:95], v31
    ds_read_b64_tr_b16 v[108:109], v34 offset:4096
    ds_read_b64_tr_b16 v[110:111], v34 offset:4608
    ds_read_b64_tr_b16 v[116:117], v34 offset:12288
    ds_read_b64_tr_b16 v[118:119], v34 offset:12800
    v_xor_b32 v31, 96, v30
    ds_read_b128 v[96:99], v31
    ds_read_b64_tr_b16 v[112:113], v34 offset:6144
    ds_read_b64_tr_b16 v[114:115], v34 offset:6656
    ds_read_b64_tr_b16 v[8:9], v34 offset:14336
    ds_read_b64_tr_b16 v[10:11], v34 offset:14848
    s_waitcnt lgkmcnt(15)
    v_mfma_f32_32x32x16_bf16 v[48:63], v[84:87], v[100:103], 0
    v_mfma_f32_32x32x16_bf16 v[64:79], v[84:87], v[36:39], 0
    s_waitcnt lgkmcnt(10)
    v_mfma_f32_32x32x16_bf16 v[48:63], v[88:91], v[104:107], v[48:63]
    v_mfma_f32_32x32x16_bf16 v[64:79], v[88:91], v[40:43], v[64:79]
    s_waitcnt lgkmcnt(5)
    v_mfma_f32_32x32x16_bf16 v[48:63], v[92:95], v[108:111], v[48:63]
    v_mfma_f32_32x32x16_bf16 v[64:79], v[92:95], v[116:119], v[64:79]
    s_waitcnt lgkmcnt(0)
    v_mfma_f32_32x32x16_bf16 v[48:63], v[96:99], v[112:115], v[48:63]
    v_mfma_f32_32x32x16_bf16 v[64:79], v[96:99], v[8:11], v[64:79]
    s_lshl_b32 s60, s44, 24
    s_add_u32 s60, s60, s75
    s_add_u32 s24, s98, s60
    s_addc_u32 s25, s99, 0
    s_lshl_b32 s64, s32, 11
    s_add_u32 s64, s64, 24064
    v_subrev_u32 v33, s72, v33
    v_add_u32 v33, s64, v33
    v_add_u32 v34, 128, v33
    v_lshlrev_b32 v35, 4, v1
    v_add_u32 v36, s64, v35
    v_add_u32 v35, s72, v35
    v_mul_f32 v48, s73, v48
    v_mul_f32 v49, s73, v49
    v_mul_f32 v50, s73, v50
    v_mul_f32 v51, s73, v51
    v_mul_f32 v52, s73, v52
    v_mul_f32 v53, s73, v53
    v_mul_f32 v54, s73, v54
    v_mul_f32 v55, s73, v55
    v_add_u32 v64, v32, v64
    v_perm_b32 v48, v48, v64, s74
    v_add_u32 v65, v32, v65
    v_perm_b32 v49, v49, v65, s74
    v_add_u32 v66, v32, v66
    v_perm_b32 v50, v50, v66, s74
    v_add_u32 v67, v32, v67
    v_perm_b32 v51, v51, v67, s74
    v_add_u32 v68, v32, v68
    v_perm_b32 v52, v52, v68, s74
    v_add_u32 v69, v32, v69
    v_perm_b32 v53, v53, v69, s74
    v_add_u32 v70, v32, v70
    v_perm_b32 v54, v54, v70, s74
    v_add_u32 v71, v32, v71
    v_perm_b32 v55, v55, v71, s74
    ds_write2st64_b32 v33, v48, v50 offset0:0 offset1:1
    ds_write2st64_b32 v34, v49, v51 offset0:0 offset1:1
    ds_write2st64_b32 v33, v52, v54 offset0:4 offset1:5
    ds_write2st64_b32 v34, v53, v55 offset0:4 offset1:5
    ds_read_b128 v[100:103], v36
    ds_read_b128 v[104:107], v36 offset:1024
    v_mul_f32 v56, s73, v56
    v_mul_f32 v57, s73, v57
    v_mul_f32 v58, s73, v58
    v_mul_f32 v59, s73, v59
    v_mul_f32 v60, s73, v60
    v_mul_f32 v61, s73, v61
    v_mul_f32 v62, s73, v62
    v_mul_f32 v63, s73, v63
    v_add_u32 v72, v32, v72
    v_perm_b32 v56, v56, v72, s74
    v_add_u32 v73, v32, v73
    v_perm_b32 v57, v57, v73, s74
    v_add_u32 v74, v32, v74
    v_perm_b32 v58, v58, v74, s74
    v_add_u32 v75, v32, v75
    v_perm_b32 v59, v59, v75, s74
    v_add_u32 v76, v32, v76
    v_perm_b32 v60, v60, v76, s74
    v_add_u32 v77, v32, v77
    v_perm_b32 v61, v61, v77, s74
    v_add_u32 v78, v32, v78
    v_perm_b32 v62, v62, v78, s74
    v_add_u32 v79, v32, v79
    v_perm_b32 v63, v63, v79, s74
    ds_write2st64_b32 v33, v56, v58 offset0:0 offset1:1
    ds_write2st64_b32 v34, v57, v59 offset0:0 offset1:1
    ds_write2st64_b32 v33, v60, v62 offset0:4 offset1:5
    ds_write2st64_b32 v34, v61, v63 offset0:4 offset1:5
    ds_read_b128 v[108:111], v36
    ds_read_b128 v[112:115], v36 offset:1024
    v_mov_b32 v120, 1416
K_SPH:
    ds_read_b32 v122, v120
    s_waitcnt lgkmcnt(0)
    v_readfirstlane_b32 s60, v122
    s_cmp_lt_u32 s60, 7
    s_cbranch_scc1 K_SPH
    s_waitcnt lgkmcnt(6)
    buffer_store_dwordx4 v[100:103], v35, s[24:27], 0 offen sc1
    buffer_store_dwordx4 v[104:107], v35, s[24:27], 0 offen offset:1024 sc1
    s_waitcnt lgkmcnt(0)
    buffer_store_dwordx4 v[108:111], v35, s[24:27], 0 offen offset:2048 sc1
    buffer_store_dwordx4 v[112:115], v35, s[24:27], 0 offen offset:3072 sc1
    v_mov_b32 v120, 1432
    v_mov_b32 v121, 1
    s_mov_b64 exec, 1
    ds_add_u32 v120, v121
    s_mov_b64 exec, -1
    v_mov_b32 v120, 1448
K_GT0:
    ds_read_b64 v[122:123], v120
    s_waitcnt lgkmcnt(0)
    v_readfirstlane_b32 s56, v122
    v_readfirstlane_b32 s57, v123
    s_and_b32 s60, s56, 3
    s_cbranch_scc0 K_GT0
    s_bfe_u32 s60, s56, 0x40004
    s_lshl_b32 s60, s60, 24
    s_add_u32 s4, s98, s60
    s_addc_u32 s5, s99, 0
    s_mul_i32 s60, s31, 3276800
    s_add_u32 s60, s60, 6291456
    s_add_u32 s8, s4, s60
    s_addc_u32 s9, s5, 0
    s_or_b32 s9, s9, 8388608
    s_and_b32 s56, s56, 0xfff00002
    s_add_u32 s60, s4, s75
    s_addc_u32 s61, s5, 0
    s_cmp_eq_u32 s60, s24
    s_cbranch_scc1 K_RGOK
    s_mov_b32 s24, s60
    s_mov_b32 s25, s61
    buffer_store_dwordx4 v[100:103], v35, s[24:27], 0 offen sc1
    buffer_store_dwordx4 v[104:107], v35, s[24:27], 0 offen offset:1024 sc1
    buffer_store_dwordx4 v[108:111], v35, s[24:27], 0 offen offset:2048 sc1
    buffer_store_dwordx4 v[112:115], v35, s[24:27], 0 offen offset:3072 sc1
K_RGOK:
    s_lshr_b32 s72, s2, 1
    s_or_b32 s72, s72, s32
    s_cmp_lg_u32 s72, 0
    s_cbranch_scc1 K_NPAD
    v_lshlrev_b32 v32, 2, v1
    v_mov_b32 v33, 0x7f000000
    s_mul_i32 s64, s31, 3276800
    s_add_u32 s64, s64, 9502720
    s_mov_b32 exec_hi, 0
    buffer_store_dword v33, v32, s[4:7], s64 offen sc1
    s_mov_b64 exec, -1
K_NPAD:
    s_waitcnt vmcnt(0)
    v_mov_b32 v120, 1428
    v_mov_b32 v121, 1
    s_mov_b64 exec, 1
    ds_add_rtn_u32 v122, v120, v121
    s_waitcnt lgkmcnt(0)
    v_readfirstlane_b32 s63, v122
    s_mov_b64 exec, -1
    s_cmp_lg_u32 s63, 13
    s_cbranch_scc1 K_NPB
    s_bitcmp1_b32 s56, 1
    s_cbranch_scc1 K_NPB
    s_call_b64 s[50:51], K_PUB
    buffer_store_dwordx4 v[40:43], v44, s[4:7], s64 offen sc1
K_NPB:
    v_and_b32 v28, 31, v1
    v_lshrrev_b32 v29, 5, v1
    v_bfe_u32 v30, v28, 1, 3
    v_xor_b32 v30, v30, v29
    v_lshlrev_b32 v30, 4, v30
    v_lshl_add_u32 v30, v28, 7, v30
    s_lshl_b32 s72, s31, 6
    v_xor_b32 v30, s72, v30
    s_lshl_b32 s72, s32, 12
    s_add_u32 s72, s72, 62080
    v_add_u32 v30, s72, v30
    v_bfe_u32 v25, v1, 2, 2
    v_lshl_add_u32 v25, v29, 3, v25
    v_lshlrev_b32 v34, 6, v25
    v_bfe_u32 v35, v1, 4, 1
    v_lshl_add_u32 v34, v35, 5, v34
    v_and_b32 v36, 1, v1
    v_bfe_u32 v37, v1, 1, 1
    v_lshl_add_u32 v36, v36, 1, v37
    v_lshl_add_u32 v34, v36, 3, v34
    s_lshl_b32 s72, s31, 11
    v_add_u32 v34, s72, v34
    v_xor_b32 v35, 2048, v34
    v_add_u32 v34, 87680, v34
    v_add_u32 v35, 87680, v35
    v_mov_b32 v120, 1432
K_SPY:
    ds_read_b32 v122, v120
    s_waitcnt lgkmcnt(0)
    v_readfirstlane_b32 s60, v122
    s_cmp_lt_u32 s60, 8
    s_cbranch_scc1 K_SPY
    v_xor_b32 v31, 0, v30
    ds_read_b128 v[76:79], v31
    ds_read_b64_tr_b16 v[104:105], v34 offset:0
    ds_read_b64_tr_b16 v[106:107], v34 offset:256
    ds_read_b64_tr_b16 v[8:9], v34 offset:4096
    ds_read_b64_tr_b16 v[10:11], v34 offset:4352
    v_xor_b32 v31, 32, v30
    ds_read_b128 v[80:83], v31
    ds_read_b64_tr_b16 v[108:109], v34 offset:1024
    ds_read_b64_tr_b16 v[110:111], v34 offset:1280
    ds_read_b64_tr_b16 v[12:13], v34 offset:5120
    ds_read_b64_tr_b16 v[14:15], v34 offset:5376
    v_xor_b32 v31, 64, v30
    ds_read_b128 v[84:87], v31
    ds_read_b64_tr_b16 v[112:113], v35 offset:0
    ds_read_b64_tr_b16 v[114:115], v35 offset:256
    ds_read_b64_tr_b16 v[16:17], v35 offset:4096
    ds_read_b64_tr_b16 v[18:19], v35 offset:4352
    v_xor_b32 v31, 96, v30
    ds_read_b128 v[88:91], v31
    ds_read_b64_tr_b16 v[116:117], v35 offset:1024
    ds_read_b64_tr_b16 v[118:119], v35 offset:1280
    ds_read_b64_tr_b16 v[40:41], v35 offset:5120
    ds_read_b64_tr_b16 v[42:43], v35 offset:5376
    s_lshl_b32 s72, s32, 5
    v_add_u32 v28, s72, v28
    v_mul_u32_u24 v24, 272, v28
    v_lshl_add_u32 v24, v29, 5, v24
    v_add_u32 v24, 7680, v24
    s_waitcnt lgkmcnt(15)
    v_mfma_f32_32x32x16_bf16 v[48:63], v[104:107], v[76:79], 0
    s_waitcnt lgkmcnt(10)
    v_mfma_f32_32x32x16_bf16 v[48:63], v[108:111], v[80:83], v[48:63]
    s_waitcnt lgkmcnt(5)
    v_mfma_f32_32x32x16_bf16 v[48:63], v[112:115], v[84:87], v[48:63]
    s_waitcnt lgkmcnt(0)
    v_mfma_f32_32x32x16_bf16 v[48:63], v[116:119], v[88:91], v[48:63]
    v_mfma_f32_32x32x16_bf16 v[104:119], v[8:11], v[76:79], 0
    v_mfma_f32_32x32x16_bf16 v[104:119], v[12:15], v[80:83], v[104:119]
    v_mfma_f32_32x32x16_bf16 v[104:119], v[16:19], v[84:87], v[104:119]
    v_mfma_f32_32x32x16_bf16 v[104:119], v[40:43], v[88:91], v[104:119]
    s_mov_b32 s73, 0xbfb8aa3b
    v_mov_b32 v31, 0xc2400000
    s_nop 5
    v_max3_f32 v32, |v48|, |v49|, |v50|
    v_max3_f32 v32, |v51|, |v52|, v32
    v_max3_f32 v32, |v53|, |v54|, v32
    v_max3_f32 v32, |v55|, |v56|, v32
    v_max3_f32 v32, |v57|, |v58|, v32
    v_max3_f32 v32, |v59|, |v60|, v32
    v_max3_f32 v32, |v61|, |v62|, v32
    v_max_f32 v32, |v63|, v32
    v_fma_f32 v48, v48, s73, v31
    v_fma_f32 v49, v49, s73, v31
    v_fma_f32 v50, v50, s73, v31
    v_fma_f32 v51, v51, s73, v31
    v_fma_f32 v52, v52, s73, v31
    v_fma_f32 v53, v53, s73, v31
    v_fma_f32 v54, v54, s73, v31
    v_fma_f32 v55, v55, s73, v31
    v_fma_f32 v56, v56, s73, v31
    v_fma_f32 v57, v57, s73, v31
    v_fma_f32 v58, v58, s73, v31
    v_fma_f32 v59, v59, s73, v31
    v_fma_f32 v60, v60, s73, v31
    v_fma_f32 v61, v61, s73, v31
    v_fma_f32 v62, v62, s73, v31
    v_fma_f32 v63, v63, s73, v31
    s_mov_b32 s72, 0x05040100
    s_mov_b32 s73, 0x07060302
    v_mov_b32 v33, 1408
    v_cmpx_gt_u32 vcc, 200, v28
    ds_write_b128 v24, v[48:51]
    ds_write_b128 v24, v[52:55] offset:16
    ds_write_b128 v24, v[56:59] offset:64
    ds_write_b128 v24, v[60:63] offset:80
    v_cvt_pk_bf16_f32 v8, v104, v105
    v_cvt_pk_bf16_f32 v9, v106, v107
    v_cvt_pk_bf16_f32 v10, v108, v109
    v_cvt_pk_bf16_f32 v11, v110, v111
    v_cvt_pk_bf16_f32 v12, v112, v113
    v_cvt_pk_bf16_f32 v13, v114, v115
    v_cvt_pk_bf16_f32 v14, v116, v117
    v_cvt_pk_bf16_f32 v15, v118, v119
    v_perm_b32 v104, v8, v76, s72
    v_perm_b32 v105, v8, v76, s73
    v_perm_b32 v106, v9, v77, s72
    v_perm_b32 v107, v9, v77, s73
    v_perm_b32 v108, v10, v78, s72
    v_perm_b32 v109, v10, v78, s73
    v_perm_b32 v110, v11, v79, s72
    v_perm_b32 v111, v11, v79, s73
    v_perm_b32 v112, v12, v80, s72
    v_perm_b32 v113, v12, v80, s73
    v_perm_b32 v114, v13, v81, s72
    v_perm_b32 v115, v13, v81, s73
    v_perm_b32 v116, v14, v82, s72
    v_perm_b32 v117, v14, v82, s73
    v_perm_b32 v118, v15, v83, s72
    v_perm_b32 v119, v15, v83, s73
    ds_write_b128 v24, v[104:107] offset:128
    ds_write_b128 v24, v[108:111] offset:144
    ds_write_b128 v24, v[112:115] offset:192
    ds_write_b128 v24, v[116:119] offset:208
    v_cmpx_gt_u32 vcc, 196, v28
    v_cmpx_nge_f32 vcc, 0x42440000, v32
    ds_write_b32 v33, v33
    s_mov_b64 exec, -1
    s_branch K_JOIN
K_BIN:
    v_mov_b32 v31, v34
    s_mul_i32 s70, s2, 782
    v_add_u32 v32, s70, v31
    v_cmp_gt_u32 vcc, 391, v31
    s_mov_b32 s71, 200000
    v_cmp_gt_u32 s[64:65], s71, v32
    s_mov_b32 s71, 199609
    v_cmp_gt_u32 s[66:67], s71, v32
    s_and_b64 s[64:65], s[64:65], vcc
    s_and_b64 s[66:67], s[66:67], vcc
    s_mov_b32 s68, 42800
    s_movk_i32 s69, 196
    v_mov_b32 v33, 1
    s_setprio 3
    s_mov_b64 exec, s[64:65]
    s_waitcnt vmcnt(5)
    v_mul_u32_u24 v48, s68, v64
    v_mul_u32_u24 v49, s68, v65
    v_mul_u32_u24 v50, s68, v66
    v_mul_u32_u24 v51, s68, v67
    v_lshrrev_b32 v48, 23, v48
    v_lshrrev_b32 v49, 23, v49
    v_lshrrev_b32 v50, 23, v50
    v_lshrrev_b32 v51, 23, v51
    v_mul_u32_u24 v84, s69, v48
    v_lshlrev_b32 v48, 2, v48
    ds_add_rtn_u32 v56, v48, v33 offset:3072
    v_mul_u32_u24 v85, s69, v49
    v_lshlrev_b32 v49, 2, v49
    ds_add_rtn_u32 v57, v49, v33 offset:3072
    v_mul_u32_u24 v86, s69, v50
    v_lshlrev_b32 v50, 2, v50
    ds_add_rtn_u32 v58, v50, v33 offset:3072
    v_mul_u32_u24 v87, s69, v51
    v_lshlrev_b32 v51, 2, v51
    ds_add_rtn_u32 v59, v51, v33 offset:3072
    v_sub_u32 v64, v64, v84
    v_sub_u32 v65, v65, v85
    v_sub_u32 v66, v66, v86
    v_sub_u32 v67, v67, v87
    s_mov_b64 exec, s[66:67]
    s_waitcnt vmcnt(4)
    v_mul_u32_u24 v52, s68, v68
    v_mul_u32_u24 v53, s68, v69
    v_mul_u32_u24 v54, s68, v70
    v_mul_u32_u24 v55, s68, v71
    v_lshrrev_b32 v52, 23, v52
    v_lshrrev_b32 v53, 23, v53
    v_lshrrev_b32 v54, 23, v54
    v_lshrrev_b32 v55, 23, v55
    v_mul_u32_u24 v88, s69, v52
    v_lshlrev_b32 v52, 2, v52
    ds_add_rtn_u32 v60, v52, v33 offset:3072
    v_mul_u32_u24 v89, s69, v53
    v_lshlrev_b32 v53, 2, v53
    ds_add_rtn_u32 v61, v53, v33 offset:3072
    v_mul_u32_u24 v90, s69, v54
    v_lshlrev_b32 v54, 2, v54
    ds_add_rtn_u32 v62, v54, v33 offset:3072
    v_mul_u32_u24 v91, s69, v55
    v_lshlrev_b32 v55, 2, v55
    ds_add_rtn_u32 v63, v55, v33 offset:3072
    v_sub_u32 v68, v68, v88
    v_sub_u32 v69, v69, v89
    v_sub_u32 v70, v70, v90
    v_sub_u32 v71, v71, v91
    s_mov_b64 exec, -1
    v_lshlrev_b32 v34, 3, v1
    v_mov_b32 v120, 1416
    v_mov_b32 v121, 1
    s_mov_b64 exec, 1
    ds_add_u32 v120, v121
    s_mov_b64 exec, -1
K_SP2:
    ds_read_b32 v122, v120
    s_waitcnt lgkmcnt(0)
    v_readfirstlane_b32 s60, v122
    s_cmp_lt_u32 s60, 7
    s_cbranch_scc1 K_SP2
    ds_read_b64 v[36:37], v34 offset:3072
    s_waitcnt lgkmcnt(0)
    v_add_u32 v36, 3, v36
    v_add_u32 v37, 3, v37
    v_and_b32 v36, -4, v36
    v_and_b32 v37, -4, v37
    v_add_u32 v38, v36, v37
    v_mov_b32 v39, v38
    s_nop 1
    v_add_u32_dpp v39, v39, v39 row_shr:1 row_mask:0xf bank_mask:0xf
    s_nop 1
    v_add_u32_dpp v39, v39, v39 row_shr:2 row_mask:0xf bank_mask:0xf
    s_nop 1
    v_add_u32_dpp v39, v39, v39 row_shr:4 row_mask:0xf bank_mask:0xf
    s_nop 1
    v_add_u32_dpp v39, v39, v39 row_shr:8 row_mask:0xf bank_mask:0xf
    s_nop 1
    v_add_u32_dpp v39, v39, v39 row_bcast:15 row_mask:0xa bank_mask:0xf
    s_nop 1
    v_add_u32_dpp v39, v39, v39 row_bcast:31 row_mask:0xc bank_mask:0xf
    v_sub_u32 v38, v39, v38
    v_add_u32 v39, v38, v36
    ds_write_b64 v34, v[38:39] offset:3584
    s_mov_b64 exec, s[64:65]
    ds_read_b32 v84, v48 offset:3584
    ds_read_b32 v85, v49 offset:3584
    ds_read_b32 v86, v50 offset:3584
    ds_read_b32 v87, v51 offset:3584
    s_mov_b64 exec, s[66:67]
    ds_read_b32 v88, v52 offset:3584
    ds_read_b32 v89, v53 offset:3584
    ds_read_b32 v90, v54 offset:3584
    ds_read_b32 v91, v55 offset:3584
    s_mov_b64 exec, -1
    v_mov_b32 v35, 95872
    s_mov_b32 s68, 0x05040100
    s_mov_b32 s69, 0x07060100
    s_waitcnt lgkmcnt(0)
    s_mov_b64 exec, s[64:65]
    v_add_u32 v84, v84, v56
    v_lshl_add_u32 v56, v84, 2, v35
    ds_write_b8 v84, v64 offset:4096
    v_add_u32 v85, v85, v57
    v_lshl_add_u32 v57, v85, 2, v35
    ds_write_b8 v85, v65 offset:4096
    v_add_u32 v86, v86, v58
    v_lshl_add_u32 v58, v86, 2, v35
    ds_write_b8 v86, v66 offset:4096
    v_add_u32 v87, v87, v59
    v_lshl_add_u32 v59, v87, 2, v35
    ds_write_b8 v87, v67 offset:4096
    s_mov_b64 exec, s[66:67]
    v_add_u32 v88, v88, v60
    v_lshl_add_u32 v60, v88, 2, v35
    ds_write_b8 v88, v68 offset:4096
    v_add_u32 v89, v89, v61
    v_lshl_add_u32 v61, v89, 2, v35
    ds_write_b8 v89, v69 offset:4096
    v_add_u32 v90, v90, v62
    v_lshl_add_u32 v62, v90, 2, v35
    ds_write_b8 v90, v70 offset:4096
    v_add_u32 v91, v91, v63
    v_lshl_add_u32 v63, v91, 2, v35
    ds_write_b8 v91, v71 offset:4096
    s_mov_b64 exec, -1
    s_waitcnt vmcnt(1)
    s_mov_b64 exec, s[64:65]
    v_perm_b32 v72, v80, v72, s68
    ds_write_b32 v56, v72
    v_perm_b32 v73, v80, v73, s69
    ds_write_b32 v57, v73
    v_perm_b32 v74, v81, v74, s68
    ds_write_b32 v58, v74
    v_perm_b32 v75, v81, v75, s69
    ds_write_b32 v59, v75
    s_waitcnt vmcnt(0)
    s_mov_b64 exec, s[66:67]
    v_perm_b32 v76, v82, v76, s68
    ds_write_b32 v60, v76
    v_perm_b32 v77, v82, v77, s69
    ds_write_b32 v61, v77
    v_perm_b32 v78, v83, v78, s68
    ds_write_b32 v62, v78
    v_perm_b32 v79, v83, v79, s69
    ds_write_b32 v63, v79
    s_mov_b64 exec, -1
    v_lshlrev_b32 v32, 4, v31
    v_add_u32 v33, 95872, v32
    s_mul_i32 s70, s2, 14336
    s_add_u32 s71, s70, 7168
    s_mul_i32 s72, s2, 3584
    s_add_u32 s72, s72, 3670016
    v_mov_b32 v120, 1420
    v_mov_b32 v121, 1
    s_mov_b64 exec, 1
    ds_add_u32 v120, v121
    s_mov_b64 exec, -1
    v_mov_b32 v120, 1448
K_GT1:
    ds_read_b64 v[122:123], v120
    s_waitcnt lgkmcnt(0)
    v_readfirstlane_b32 s56, v122
    v_readfirstlane_b32 s57, v123
    s_and_b32 s60, s56, 3
    s_cbranch_scc0 K_GT1
    s_bfe_u32 s60, s56, 0x40004
    s_lshl_b32 s60, s60, 24
    s_add_u32 s4, s98, s60
    s_addc_u32 s5, s99, 0
    s_mul_i32 s60, s31, 3276800
    s_add_u32 s60, s60, 6291456
    s_add_u32 s8, s4, s60
    s_addc_u32 s9, s5, 0
    s_or_b32 s9, s9, 8388608
    s_and_b32 s56, s56, 0xfff00002
    v_mov_b32 v120, 1420
K_SP3:
    ds_read_b32 v122, v120
    s_waitcnt lgkmcnt(0)
    v_readfirstlane_b32 s60, v122
    s_cmp_lt_u32 s60, 7
    s_cbranch_scc1 K_SP3
    ds_read_b128 v[64:67], v33
    ds_read_b128 v[68:71], v33 offset:7168
    ds_read_b128 v[72:75], v32 offset:4096
    v_cmp_gt_u32 vcc, 224, v31
    s_waitcnt lgkmcnt(2)
    buffer_store_dwordx4 v[64:67], v32, s[4:7], s70 offen sc1
    s_waitcnt lgkmcnt(1)
    buffer_store_dwordx4 v[68:71], v32, s[4:7], s71 offen sc1
    s_waitcnt lgkmcnt(0)
    s_and_saveexec_b64 s[64:65], vcc
    s_cbranch_execz K_NLOC
    buffer_store_dwordx4 v[72:75], v32, s[4:7], s72 offen sc1
K_NLOC:
    s_mov_b64 exec, -1
    v_mov_b32 v76, 25088
    v_mov_b32 v77, 25088
    v_mov_b32 v78, 25088
    v_mov_b32 v79, 25088
    ds_write_b128 v33, v[76:79]
    ds_write_b128 v33, v[76:79] offset:7168
    s_call_b64 s[50:51], K_PUB
    s_waitcnt vmcnt(0)
    v_mov_b32 v120, 1428
    v_mov_b32 v121, 1
    s_mov_b64 exec, 1
    ds_add_rtn_u32 v122, v120, v121
    s_waitcnt lgkmcnt(0)
    v_readfirstlane_b32 s63, v122
    s_mov_b64 exec, -1
    s_branch K_PUBQ
K_HELP:
    s_cmp_lg_u32 s32, 15
    s_cbranch_scc1 K_NTG
    s_load_dwordx2 s[56:57], s[96:97], 0
    s_waitcnt lgkmcnt(0)
    s_bitcmp1_b32 s56, 0
    s_cbranch_scc1 K_TG2
    s_sleep 4
    s_load_dwordx2 s[56:57], s[96:97], 64
    s_waitcnt lgkmcnt(0)
    s_bitcmp1_b32 s56, 0
    s_cbranch_scc1 K_TG2
    s_sleep 4
    s_load_dwordx2 s[56:57], s[96:97], 128
    s_waitcnt lgkmcnt(0)
    s_bitcmp1_b32 s56, 0
    s_cbranch_scc1 K_TG2
    s_sleep 4
    s_load_dwordx2 s[56:57], s[96:97], 192
    s_waitcnt lgkmcnt(0)
    s_bitcmp1_b32 s56, 0
    s_cbranch_scc1 K_TG2
    s_sleep 4
    s_mov_b32 s24, s96
    s_mov_b32 s25, s97
    s_mov_b32 s26, 256
    s_mov_b32 s27, 0x20000
    v_mov_b32 v34, 0
    s_mov_b32 s73, 30000
K_TG:
    buffer_load_dwordx2 v[32:33], v34, s[24:27], 0 offen sc1
    s_waitcnt vmcnt(0)
    v_readfirstlane_b32 s56, v32
    v_readfirstlane_b32 s57, v33
    s_bitcmp1_b32 s56, 0
    s_cbranch_scc1 K_TG2
    s_sleep 2
    s_sub_u32 s73, s73, 1
    s_cmp_lg_u32 s73, 0
    s_cbranch_scc1 K_TG
    s_mov_b32 s56, 2
K_TG2:
    v_mov_b32 v32, s56
    v_mov_b32 v33, s57
    v_mov_b32 v35, 1448
    ds_write_b64 v35, v[32:33]
    v_mov_b32 v120, 1448
K_GT3:
    ds_read_b64 v[122:123], v120
    s_waitcnt lgkmcnt(0)
    v_readfirstlane_b32 s56, v122
    v_readfirstlane_b32 s57, v123
    s_and_b32 s60, s56, 3
    s_cbranch_scc0 K_GT3
    s_bfe_u32 s60, s56, 0x40004
    s_lshl_b32 s60, s60, 24
    s_add_u32 s4, s98, s60
    s_addc_u32 s5, s99, 0
    s_mul_i32 s60, s31, 3276800
    s_add_u32 s60, s60, 6291456
    s_add_u32 s8, s4, s60
    s_addc_u32 s9, s5, 0
    s_or_b32 s9, s9, 8388608
    s_and_b32 s56, s56, 0xfff00002
    s_waitcnt vmcnt(0)
    s_branch K_JOIN
K_NTG:
    s_xor_b32 s63, s31, 1
    s_mul_i32 s63, s63, 12288
    s_add_u32 m0, s63, 62080
    s_add_u32 s63, s63, s67
    v_lshrrev_b32 v30, 2, v1
    v_lshlrev_b32 v30, 7, v30
    v_and_b32 v31, 3, v1
    v_lshl_add_u32 v30, v31, 4, v30
    s_mov_b32 s20, s84
    s_mov_b32 s21, s85
    s_mov_b32 s22, 8192
    s_mov_b32 s23, 0x20000
    s_mov_b32 s24, s90
    s_mov_b32 s25, s91
    s_mov_b32 s26, 8192
    s_mov_b32 s27, 0x20000
K_SPE:
    ds_read_b32 v122, v120
    s_waitcnt lgkmcnt(0)
    v_readfirstlane_b32 s60, v122
    s_cmp_lt_u32 s60, 16
    s_cbranch_scc1 K_SPE
    buffer_load_dwordx4 v24, s[16:19], s63 offen lds
    buffer_load_dwordx4 v25, s[16:19], s63 offen offset:1024 lds
    buffer_load_dwordx4 v24, s[16:19], s63 offen offset:2048 lds
    buffer_load_dwordx4 v25, s[16:19], s63 offen offset:3072 lds
    s_add_u32 m0, m0, 4096
    s_add_u32 s63, s63, 4096
    buffer_load_dwordx4 v24, s[16:19], s63 offen lds
    buffer_load_dwordx4 v25, s[16:19], s63 offen offset:1024 lds
    buffer_load_dwordx4 v24, s[16:19], s63 offen offset:2048 lds
    buffer_load_dwordx4 v25, s[16:19], s63 offen offset:3072 lds
    s_add_u32 m0, m0, 4096
    s_add_u32 s63, s63, 4096
    buffer_load_dwordx4 v24, s[16:19], s63 offen lds
    buffer_load_dwordx4 v25, s[16:19], s63 offen offset:1024 lds
    buffer_load_dwordx4 v24, s[16:19], s63 offen offset:2048 lds
    buffer_load_dwordx4 v25, s[16:19], s63 offen offset:3072 lds
    s_add_u32 m0, m0, 4096
    s_add_u32 s63, s63, 4096
    s_mov_b32 m0, 87680
    s_mov_b32 s64, s66
    buffer_load_dwordx4 v30, s[20:23], s64 offen offset:0 lds
    s_add_u32 s64, s64, 1024
    buffer_load_dwordx4 v30, s[20:23], s64 offen offset:1024 lds
    s_add_u32 s64, s64, 1024
    buffer_load_dwordx4 v30, s[20:23], s64 offen offset:2048 lds
    s_add_u32 s64, s64, 1024
    buffer_load_dwordx4 v30, s[20:23], s64 offen offset:3072 lds
    s_add_u32 s64, s64, 1024
    s_mov_b32 m0, 91776
    s_mov_b32 s64, s66
    buffer_load_dwordx4 v30, s[24:27], s64 offen offset:0 lds
    s_add_u32 s64, s64, 1024
    buffer_load_dwordx4 v30, s[24:27], s64 offen offset:1024 lds
    s_add_u32 s64, s64, 1024
    buffer_load_dwordx4 v30, s[24:27], s64 offen offset:2048 lds
    s_add_u32 s64, s64, 1024
    buffer_load_dwordx4 v30, s[24:27], s64 offen offset:3072 lds
    s_add_u32 s64, s64, 1024
    s_waitcnt vmcnt(0)
    v_mov_b32 v120, 1432
    v_mov_b32 v121, 1
    s_mov_b64 exec, 1
    ds_add_u32 v120, v121
    s_mov_b64 exec, -1
    v_mov_b32 v120, 1448
K_GT2:
    ds_read_b64 v[122:123], v120
    s_waitcnt lgkmcnt(0)
    v_readfirstlane_b32 s56, v122
    v_readfirstlane_b32 s57, v123
    s_and_b32 s60, s56, 3
    s_cbranch_scc0 K_GT2
    s_bfe_u32 s60, s56, 0x40004
    s_lshl_b32 s60, s60, 24
    s_add_u32 s4, s98, s60
    s_addc_u32 s5, s99, 0
    s_mul_i32 s60, s31, 3276800
    s_add_u32 s60, s60, 6291456
    s_add_u32 s8, s4, s60
    s_addc_u32 s9, s5, 0
    s_or_b32 s9, s9, 8388608
    s_and_b32 s56, s56, 0xfff00002
    s_branch K_JOIN
K_PUB:
    v_lshlrev_b32 v122, 3, v1
    ds_read_b64 v[36:37], v122 offset:3072
    ds_read_b64 v[38:39], v122 offset:3584
    s_lshl_b32 s64, s2, 10
    s_add_u32 s64, s64, 4587520
    v_lshlrev_b32 v44, 4, v1
    v_mov_b32 v41, s57
    v_mov_b32 v43, s57
    s_waitcnt lgkmcnt(0)
    v_add_u32 v36, 3, v36
    v_add_u32 v37, 3, v37
    v_lshrrev_b32 v36, 2, v36
    v_lshrrev_b32 v37, 2, v37
    v_lshrrev_b32 v38, 2, v38
    v_lshrrev_b32 v39, 2, v39
    v_lshl_or_b32 v40, v36, 10, v38
    v_lshl_or_b32 v42, v37, 10, v39
    v_or_b32 v40, s56, v40
    v_or_b32 v42, s56, v42
    s_setpc_b64 s[50:51]
K_PUBQ:
    s_cmp_lg_u32 s63, 13
    s_cbranch_scc1 K_JOIN
    s_bitcmp1_b32 s56, 1
    s_cbranch_scc1 K_JOIN
    buffer_store_dwordx4 v[40:43], v44, s[4:7], s64 offen sc1
K_JOIN:
    s_setprio 0
    v_lshrrev_b32 v28, 3, v0
    v_lshlrev_b32 v24, 10, v28
    v_and_b32 v26, 7, v1
    v_mul_u32_u24 v28, 896, v28
    v_add_u32 v28, v28, v26
    s_lshl_b32 s65, s30, 3
    s_add_u32 s65, s65, 4587520
    s_add_u32 s74, s65, 131072
    s_mov_b32 s62, 1835008
    s_mov_b32 s63, 3670016
    s_mov_b32 s64, 4128768
    v_mov_b32 v31, 0x04000000
    v_mov_b32 v38, 4
    v_mov_b32 v39, 2
    v_add_u32 v25, 8, v26
    v_min_u32 v30, 783, v0
    v_lshlrev_b32 v30, 7, v30
    s_mov_b32 s72, 0xfff00000
    s_mov_b32 s73, 30000
    v_lshlrev_b32 v20, 16, v22
    v_and_b32 v21, s49, v22
    v_lshlrev_b32 v22, 16, v23
    v_and_b32 v23, s49, v23
    s_mov_b32 s60, 0xbfb8aa3b
    v_mul_f32 v20, s60, v20
    v_mul_f32 v21, s60, v21
    v_mul_f32 v22, s60, v22
    v_mul_f32 v23, s60, v23
    v_mov_b32 v96, 0
    v_mov_b32 v97, 0
    v_mov_b32 v98, 0
    v_mov_b32 v99, 0
    v_mov_b32 v100, 0
    v_mov_b32 v101, 0
    s_waitcnt lgkmcnt(0)
    s_barrier
    s_bitcmp1_b32 s56, 1
    s_cselect_b32 s73, 1, s73
K_POLL:
    buffer_load_dwordx2 v[32:33], v24, s[4:7], s65 offen sc1
    buffer_load_dwordx2 v[34:35], v24, s[4:7], s74 offen sc1
    s_waitcnt vmcnt(0)
    v_and_b32 v36, s72, v32
    v_and_b32 v37, s72, v34
    v_cmp_eq_u32 vcc, s57, v33
    v_cmp_eq_u32 s[66:67], s57, v35
    v_cmp_eq_u32 s[68:69], s56, v36
    v_cmp_eq_u32 s[70:71], s56, v37
    s_and_b64 vcc, vcc, s[66:67]
    s_and_b64 s[68:69], s[68:69], s[70:71]
    s_and_b64 vcc, vcc, s[68:69]
    s_cmp_eq_u64 vcc, -1
    s_cbranch_scc1 K_GOT
    s_sleep 8
    s_sub_u32 s73, s73, 1
    s_cmp_lg_u32 s73, 0
    s_cbranch_scc1 K_POLL
    v_mov_b32 v37, 1408
    ds_write_b32 v37, v38
    v_mov_b32 v32, 0
    v_mov_b32 v34, 0
K_GOT:
    v_bfe_u32 v40, v32, 10, 10
    v_bfe_u32 v41, v34, 10, 10
    v_and_b32 v32, 0x3ff, v32
    v_and_b32 v33, 0x3ff, v34
    v_cmp_lt_u32 s[66:67], v26, v40
    v_cmp_lt_u32 s[68:69], v26, v41
    v_add_u32 v32, v32, v28
    v_add_u32 v33, v33, v28
    v_cndmask_b32 v42, v31, v32, s[66:67]
    v_cndmask_b32 v43, v31, v33, s[68:69]
    v_lshlrev_b32 v36, 2, v42
    v_lshlrev_b32 v37, 2, v43
    v_lshlrev_b32 v42, 4, v42
    v_lshlrev_b32 v43, 4, v43
    buffer_load_dword v72, v36, s[4:7], s63 offen sc1
    buffer_load_dword v73, v37, s[4:7], s64 offen sc1
    buffer_load_dwordx4 v[64:67], v42, s[4:7], 0 offen sc1
    buffer_load_dwordx4 v[68:71], v43, s[4:7], s62 offen sc1
    v_cmp_lt_u32 s[70:71], v25, v40
    v_cmp_lt_u32 s[72:73], v25, v41
    s_mov_b64 exec, s[70:71]
    s_cbranch_execz K_OV0
    buffer_load_dword v74, v36, s[4:7], s63 offen offset:32 sc1
    buffer_load_dwordx4 v[76:79], v42, s[4:7], 0 offen offset:128 sc1
K_OV0:
    s_mov_b64 exec, s[72:73]
    s_cbranch_execz K_OV1
    buffer_load_dword v75, v37, s[4:7], s64 offen offset:32 sc1
    buffer_load_dwordx4 v[104:107], v43, s[4:7], s62 offen offset:128 sc1
K_OV1:
    s_mov_b64 exec, -1
    v_max_u32 v36, v40, v41
    v_mov_b32 v37, 1408
    v_cmpx_lt_u32 vcc, 16, v36
    ds_write_b32 v37, v38
    s_mov_b64 exec, -1
    v_mov_b32 v120, 1440
    v_mov_b32 v121, 1
    s_mov_b64 exec, 1
    ds_add_u32 v120, v121
    s_mov_b64 exec, -1
    s_waitcnt vmcnt(0)
    s_mov_b64 exec, s[66:67]
    v_lshlrev_b32_sdwa v80, v39, v72 dst_sel:DWORD dst_unused:UNUSED_PAD src0_sel:DWORD src1_sel:BYTE_0
    ds_add_rtn_u32 v80, v80, v38
    v_lshlrev_b32_sdwa v81, v39, v72 dst_sel:DWORD dst_unused:UNUSED_PAD src0_sel:DWORD src1_sel:BYTE_1
    ds_add_rtn_u32 v81, v81, v38
    v_lshlrev_b32_sdwa v82, v39, v72 dst_sel:DWORD dst_unused:UNUSED_PAD src0_sel:DWORD src1_sel:BYTE_2
    ds_add_rtn_u32 v82, v82, v38
    v_lshlrev_b32_sdwa v83, v39, v72 dst_sel:DWORD dst_unused:UNUSED_PAD src0_sel:DWORD src1_sel:BYTE_3
    ds_add_rtn_u32 v83, v83, v38
    s_mov_b64 exec, s[68:69]
    v_lshlrev_b32_sdwa v84, v39, v73 dst_sel:DWORD dst_unused:UNUSED_PAD src0_sel:DWORD src1_sel:BYTE_0
    ds_add_rtn_u32 v84, v84, v38
    v_lshlrev_b32_sdwa v85, v39, v73 dst_sel:DWORD dst_unused:UNUSED_PAD src0_sel:DWORD src1_sel:BYTE_1
    ds_add_rtn_u32 v85, v85, v38
    v_lshlrev_b32_sdwa v86, v39, v73 dst_sel:DWORD dst_unused:UNUSED_PAD src0_sel:DWORD src1_sel:BYTE_2
    ds_add_rtn_u32 v86, v86, v38
    v_lshlrev_b32_sdwa v87, v39, v73 dst_sel:DWORD dst_unused:UNUSED_PAD src0_sel:DWORD src1_sel:BYTE_3
    ds_add_rtn_u32 v87, v87, v38
    s_mov_b64 exec, s[70:71]
    s_cbranch_execz K_IA0
    v_lshlrev_b32_sdwa v88, v39, v74 dst_sel:DWORD dst_unused:UNUSED_PAD src0_sel:DWORD src1_sel:BYTE_0
    ds_add_rtn_u32 v88, v88, v38
    v_lshlrev_b32_sdwa v89, v39, v74 dst_sel:DWORD dst_unused:UNUSED_PAD src0_sel:DWORD src1_sel:BYTE_1
    ds_add_rtn_u32 v89, v89, v38
    v_lshlrev_b32_sdwa v90, v39, v74 dst_sel:DWORD dst_unused:UNUSED_PAD src0_sel:DWORD src1_sel:BYTE_2
    ds_add_rtn_u32 v90, v90, v38
    v_lshlrev_b32_sdwa v91, v39, v74 dst_sel:DWORD dst_unused:UNUSED_PAD src0_sel:DWORD src1_sel:BYTE_3
    ds_add_rtn_u32 v91, v91, v38
K_IA0:
    s_mov_b64 exec, s[72:73]
    s_cbranch_execz K_IA1
    v_lshlrev_b32_sdwa v92, v39, v75 dst_sel:DWORD dst_unused:UNUSED_PAD src0_sel:DWORD src1_sel:BYTE_0
    ds_add_rtn_u32 v92, v92, v38
    v_lshlrev_b32_sdwa v93, v39, v75 dst_sel:DWORD dst_unused:UNUSED_PAD src0_sel:DWORD src1_sel:BYTE_1
    ds_add_rtn_u32 v93, v93, v38
    v_lshlrev_b32_sdwa v94, v39, v75 dst_sel:DWORD dst_unused:UNUSED_PAD src0_sel:DWORD src1_sel:BYTE_2
    ds_add_rtn_u32 v94, v94, v38
    v_lshlrev_b32_sdwa v95, v39, v75 dst_sel:DWORD dst_unused:UNUSED_PAD src0_sel:DWORD src1_sel:BYTE_3
    ds_add_rtn_u32 v95, v95, v38
    s_waitcnt lgkmcnt(0)
    ds_write_b32 v92, v104
    ds_write_b32 v93, v105
    ds_write_b32 v94, v106
    ds_write_b32 v95, v107
K_IA1:
    s_mov_b64 exec, s[68:69]
    s_waitcnt lgkmcnt(0)
    ds_write_b32 v84, v68
    ds_write_b32 v85, v69
    ds_write_b32 v86, v70
    ds_write_b32 v87, v71
    s_mov_b64 exec, s[66:67]
    ds_write_b32 v80, v64
    ds_write_b32 v81, v65
    ds_write_b32 v82, v66
    ds_write_b32 v83, v67
    s_mov_b64 exec, s[70:71]
    s_cbranch_execz K_IW0
    ds_write_b32 v88, v76
    ds_write_b32 v89, v77
    ds_write_b32 v90, v78
    ds_write_b32 v91, v79
K_IW0:
    s_mov_b64 exec, -1
K_SPM:
    ds_read_b32 v122, v120
    s_waitcnt lgkmcnt(0)
    v_readfirstlane_b32 s60, v122
    s_cmp_lt_u32 s60, 16
    s_cbranch_scc1 K_SPM
    s_cmp_lt_u32 s32, 0
    s_cbranch_scc1 K_NPFB
    s_cmp_ge_u32 s32, 5
    s_cbranch_scc1 K_NPFB
    buffer_load_ubyte v126, v30, s[4:7], s58 offen sc1
K_NPFB:
K_IND:
    s_barrier
    s_cmp_ge_u32 s32, 4
    s_cbranch_scc1 K_S1
    s_setprio 3
    v_lshlrev_b32 v28, 2, v0
    ds_read_b32 v29, v28
    v_mul_u32_u24 v30, 296, v0
    v_add_u32 v30, 95868, v30
    v_cmp_gt_u32 vcc, 200, v0
    s_mov_b64 s[66:67], vcc
    v_cmp_gt_u32 vcc, 196, v0
    v_mov_b32 v37, 1408
    v_mov_b32 v36, 1
    s_waitcnt lgkmcnt(0)
    v_sub_u32 v29, v29, v30
    v_lshrrev_b32 v29, 3, v29
    v_max_u32 v31, 1, v29
    v_min_u32 v31, 63, v31
    v_cndmask_b32 v31, 0, v31, vcc
    v_lshlrev_b32 v32, 2, v31
    v_sub_u32 v32, 252, v32
    s_mov_b64 exec, s[66:67]
    ds_add_rtn_u32 v33, v32, v36 offset:1024
    v_cmpx_lt_u32 vcc, 37, v29
    ds_write_b32 v37, v38
    s_mov_b64 exec, -1
    v_lshlrev_b32 v34, 2, v1
    s_waitcnt lgkmcnt(0)
K_S1:
    s_barrier
    s_cmp_ge_u32 s32, 4
    s_cbranch_scc1 K_S2
    ds_read_b32 v35, v34 offset:1024
    s_waitcnt lgkmcnt(0)
    v_mov_b32 v36, v35
    s_nop 1
    v_add_u32_dpp v36, v36, v36 row_shr:1 row_mask:0xf bank_mask:0xf
    s_nop 1
    v_add_u32_dpp v36, v36, v36 row_shr:2 row_mask:0xf bank_mask:0xf
    s_nop 1
    v_add_u32_dpp v36, v36, v36 row_shr:4 row_mask:0xf bank_mask:0xf
    s_nop 1
    v_add_u32_dpp v36, v36, v36 row_shr:8 row_mask:0xf bank_mask:0xf
    s_nop 1
    v_add_u32_dpp v36, v36, v36 row_bcast:15 row_mask:0xa bank_mask:0xf
    s_nop 1
    v_add_u32_dpp v36, v36, v36 row_bcast:31 row_mask:0xc bank_mask:0xf
    v_sub_u32 v36, v36, v35
    ds_bpermute_b32 v36, v32, v36
    s_waitcnt lgkmcnt(0)
    v_add_u32 v33, v33, v36
    v_lshlrev_b32 v36, 2, v33
    v_and_b32 v35, 7, v33
    v_lshrrev_b32 v33, 1, v33
    s_mov_b64 exec, s[66:67]
    ds_write_b32 v36, v0 offset:1536
    v_cmpx_eq_u32 vcc, 0, v35
    ds_write_b32 v33, v31 offset:1280
    s_mov_b64 exec, -1
K_S2:
    v_and_b32 v34, 31, v1
    v_lshlrev_b32 v34, 2, v34
    v_mov_b32 v37, 1408
    s_and_b32 s33, s32, 3
    s_lshl_b32 s33, s33, 2
    s_lshr_b32 s60, s32, 2
    s_add_u32 s33, s33, s60
    s_waitcnt lgkmcnt(0)
    s_barrier
    s_setprio 3
    ds_read_b32 v35, v34 offset:1280
    ds_read_b32 v38, v37
    s_waitcnt lgkmcnt(0)
    v_mov_b32 v36, v35
    v_readfirstlane_b32 s60, v38
    s_cmp_lg_u32 s60, 0
    s_cbranch_scc1 K_SLOW
    v_add_u32_dpp v36, v36, v36 row_shr:1 row_mask:0xf bank_mask:0xf
    s_nop 1
    v_add_u32_dpp v36, v36, v36 row_shr:2 row_mask:0xf bank_mask:0xf
    s_nop 1
    v_add_u32_dpp v36, v36, v36 row_shr:4 row_mask:0xf bank_mask:0xf
    s_nop 1
    v_add_u32_dpp v36, v36, v36 row_shr:8 row_mask:0xf bank_mask:0xf
    s_nop 1
    v_add_u32_dpp v36, v36, v36 row_bcast:15 row_mask:0xa bank_mask:0xf
    s_nop 0
    v_readlane_b32 s47, v36, 31
    s_mul_i32 s61, s33, s47
    s_add_u32 s62, s61, s47
    s_lshr_b32 s61, s61, 4
    s_lshr_b32 s62, s62, 4
    s_sub_u32 s42, s62, s61
    s_sub_u32 s42, s42, 1
    s_min_u32 s42, s42, 58
    v_cmp_ge_u32 vcc, s61, v36
    s_bcnt1_i32_b32 s43, vcc_lo
    s_lshl_b32 s63, s43, 5
    v_add_u32 v4, s63, v4
    ds_read_b32 v7, v4 offset:1536
    ds_read_b32 v60, v4 offset:1568
    v_sub_u32 v35, v36, v35
    s_nop 0
    v_readlane_b32 s48, v35, s43
    s_mov_b32 s44, s43
    v_subrev_u32 v36, s61, v36
    v_subrev_u32 v36, 1, v36
    v_cmp_gt_u32 vcc, 64, v36
    v_mov_b32 v40, 1
    v_mov_b32 v41, 0
    v_lshlrev_b64 v[40:41], v36, v[40:41]
    v_cndmask_b32 v40, 0, v40, vcc
    v_cndmask_b32 v41, 0, v41, vcc
    s_nop 0
    v_or_b32_dpp v40, v40, v40 row_shr:1 row_mask:0xf bank_mask:0xf
    v_or_b32_dpp v41, v41, v41 row_shr:1 row_mask:0xf bank_mask:0xf
    s_nop 0
    v_or_b32_dpp v40, v40, v40 row_shr:2 row_mask:0xf bank_mask:0xf
    v_or_b32_dpp v41, v41, v41 row_shr:2 row_mask:0xf bank_mask:0xf
    s_nop 0
    v_or_b32_dpp v40, v40, v40 row_shr:4 row_mask:0xf bank_mask:0xf
    v_or_b32_dpp v41, v41, v41 row_shr:4 row_mask:0xf bank_mask:0xf
    s_nop 0
    v_or_b32_dpp v40, v40, v40 row_shr:8 row_mask:0xf bank_mask:0xf
    v_or_b32_dpp v41, v41, v41 row_shr:8 row_mask:0xf bank_mask:0xf
    s_nop 0
    v_or_b32_dpp v40, v40, v40 row_bcast:15 row_mask:0xa bank_mask:0xf
    v_or_b32_dpp v41, v41, v41 row_bcast:15 row_mask:0xa bank_mask:0xf
    v_readlane_b32 s38, v40, 31
    v_readlane_b32 s39, v41, 31
    s_sub_u32 s64, s61, s48
    s_cmp_lg_u32 s64, 0
    s_cselect_b32 s45, 1, 0
    s_lshl_b32 s64, s64, 3
    s_add_u32 s64, s64, 95872
    s_movk_i32 s65, 296
    v_mov_b32 v36, s64
    s_waitcnt lgkmcnt(0)
    v_mad_u32_u24 v2, v7, s65, v36
    v_mov_b32 v3, v60
    ds_read_u16 v44, v2 offset:0
    ds_read_u16 v46, v2 offset:4
    ds_read_u16_d16_hi v96, v2 offset:2
    ds_read_u16_d16_hi v97, v2 offset:6
    s_movk_i32 s65, 272
    v_mad_u32_u24 v36, v7, s65, v5
    ds_read_b128 v[16:19], v36
    ds_read_b128 v[56:59], v36 offset:128
    v_mad_u32_u24 v36, v60, s65, v5
    ds_read_b128 v[116:119], v36
    v_add_u32 v2, 8, v2
    s_bitcmp1_b64 s[38:39], 0
    s_cbranch_scc0 K_PR0
    s_mov_b32 s46, -1
    s_call_b64 s[52:53], K_FETCH
K_PR0:
    s_waitcnt lgkmcnt(0)
    buffer_load_dwordx4 v[64:67], v[44:45], s[8:11], 0 idxen offen sc1
    buffer_load_dwordx4 v[68:71], v[46:47], s[8:11], 0 idxen offen sc1
    ds_read_u16 v44, v2 offset:0
    ds_read_u16 v46, v2 offset:4
    ds_read_u16_d16_hi v98, v2 offset:2
    ds_read_u16_d16_hi v99, v2 offset:6
    v_add_u32 v2, 8, v2
    s_bitcmp1_b64 s[38:39], 1
    s_cbranch_scc0 K_PR1
    s_mov_b32 s46, -1
    s_call_b64 s[52:53], K_FETCH
K_PR1:
    s_waitcnt lgkmcnt(0)
    buffer_load_dwordx4 v[72:75], v[44:45], s[8:11], 0 idxen offen sc1
    buffer_load_dwordx4 v[76:79], v[46:47], s[8:11], 0 idxen offen sc1
    ds_read_u16 v44, v2 offset:0
    ds_read_u16 v46, v2 offset:4
    ds_read_u16_d16_hi v100, v2 offset:2
    ds_read_u16_d16_hi v101, v2 offset:6
    v_add_u32 v2, 8, v2
    s_bitcmp1_b64 s[38:39], 2
    s_cbranch_scc0 K_PR2
    s_mov_b32 s46, -1
    s_call_b64 s[52:53], K_FETCH
K_PR2:
    s_lshr_b64 s[40:41], s[38:39], 3
    s_or_b64 s[34:35], s[38:39], s[40:41]
    s_lshl_b64 s[60:61], 1, s42
    s_or_b64 s[34:35], s[34:35], s[60:61]
    s_lshr_b64 s[62:63], s[60:61], 2
    s_or_b64 s[34:35], s[34:35], s[62:63]
    s_lshr_b64 s[62:63], s[60:61], 4
    s_or_b64 s[34:35], s[34:35], s[62:63]
    s_lshr_b64 s[62:63], s[60:61], 7
    s_or_b64 s[34:35], s[34:35], s[62:63]
    s_mov_b64 s[36:37], s[34:35]
    v_exp_f32 v16, v16
    v_exp_f32 v17, v17
    v_exp_f32 v18, v18
    v_exp_f32 v19, v19
    v_mov_b32 v8, 0
    v_mov_b32 v9, 0
    v_mov_b32 v10, 0
    v_mov_b32 v11, 0
    v_mov_b32 v12, 0
    v_mov_b32 v13, 0
    v_mov_b32 v14, 0
    v_mov_b32 v15, 0
    .p2align 6
K_LOOP:
    s_waitcnt vmcnt(2) lgkmcnt(0)
    v_pk_fma_f32 v[24:25], v[96:97], v[20:21], v[64:65] op_sel_hi:[0,1,1]
    v_pk_fma_f32 v[26:27], v[96:97], v[22:23], v[66:67] op_sel_hi:[0,1,1]
    v_pk_fma_f32 v[28:29], v[96:97], v[20:21], v[68:69] op_sel:[1,0,0] op_sel_hi:[1,1,1]
    v_pk_fma_f32 v[30:31], v[96:97], v[22:23], v[70:71] op_sel:[1,0,0] op_sel_hi:[1,1,1]
    v_lshlrev_b64 v[32:33], 16, v[64:65]
    v_lshlrev_b64 v[34:35], 16, v[66:67]
    v_lshlrev_b64 v[36:37], 16, v[68:69]
    v_lshlrev_b64 v[38:39], 16, v[70:71]
    buffer_load_dwordx4 v[64:67], v[44:45], s[8:11], 0 idxen offen sc1
    buffer_load_dwordx4 v[68:71], v[46:47], s[8:11], 0 idxen offen sc1
    ds_read_u16 v44, v2 offset:0
    ds_read_u16 v46, v2 offset:4
    ds_read_u16_d16_hi v96, v2 offset:2
    ds_read_u16_d16_hi v97, v2 offset:6
    v_exp_f32 v24, v24
    v_exp_f32 v25, v25
    v_exp_f32 v26, v26
    v_exp_f32 v27, v27
    v_exp_f32 v28, v28
    v_exp_f32 v29, v29
    v_exp_f32 v30, v30
    v_exp_f32 v31, v31
    v_pk_fma_f32 v[24:25], v[24:25], v[16:17], s[28:29] clamp
    v_pk_fma_f32 v[26:27], v[26:27], v[18:19], s[28:29] clamp
    v_pk_fma_f32 v[28:29], v[28:29], v[16:17], s[28:29] clamp
    v_pk_fma_f32 v[30:31], v[30:31], v[18:19], s[28:29] clamp
    v_pk_mul_f32 v[40:41], v[24:25], v[28:29]
    v_pk_mul_f32 v[42:43], v[26:27], v[30:31]
    v_rcp_f32 v40, v40
    v_rcp_f32 v41, v41
    v_rcp_f32 v42, v42
    v_rcp_f32 v43, v43
    v_pk_add_f32 v[48:49], v[24:25], v[28:29]
    v_pk_add_f32 v[50:51], v[26:27], v[30:31]
    v_pk_mul_f32 v[52:53], v[32:33], v[28:29]
    v_pk_mul_f32 v[54:55], v[34:35], v[30:31]
    v_pk_fma_f32 v[52:53], v[36:37], v[24:25], v[52:53]
    v_pk_fma_f32 v[54:55], v[38:39], v[26:27], v[54:55]
    v_pk_fma_f32 v[12:13], v[48:49], v[40:41], v[12:13]
    v_pk_fma_f32 v[14:15], v[50:51], v[42:43], v[14:15]
    v_pk_fma_f32 v[8:9], v[52:53], v[40:41], v[8:9]
    v_pk_fma_f32 v[10:11], v[54:55], v[42:43], v[10:11]
    s_bitcmp1_b64 s[34:35], 0
    s_cbranch_scc1 K_EV0
K_RT0:
    s_waitcnt vmcnt(2) lgkmcnt(0)
    v_pk_fma_f32 v[24:25], v[98:99], v[20:21], v[72:73] op_sel_hi:[0,1,1]
    v_pk_fma_f32 v[26:27], v[98:99], v[22:23], v[74:75] op_sel_hi:[0,1,1]
    v_pk_fma_f32 v[28:29], v[98:99], v[20:21], v[76:77] op_sel:[1,0,0] op_sel_hi:[1,1,1]
    v_pk_fma_f32 v[30:31], v[98:99], v[22:23], v[78:79] op_sel:[1,0,0] op_sel_hi:[1,1,1]
    v_lshlrev_b64 v[32:33], 16, v[72:73]
    v_lshlrev_b64 v[34:35], 16, v[74:75]
    v_lshlrev_b64 v[36:37], 16, v[76:77]
    v_lshlrev_b64 v[38:39], 16, v[78:79]
    buffer_load_dwordx4 v[72:75], v[44:45], s[8:11], 0 idxen offen sc1
    buffer_load_dwordx4 v[76:79], v[46:47], s[8:11], 0 idxen offen sc1
    ds_read_u16 v44, v2 offset:8
    ds_read_u16 v46, v2 offset:12
    ds_read_u16_d16_hi v98, v2 offset:10
    ds_read_u16_d16_hi v99, v2 offset:14
    v_exp_f32 v24, v24
    v_exp_f32 v25, v25
    v_exp_f32 v26, v26
    v_exp_f32 v27, v27
    v_exp_f32 v28, v28
    v_exp_f32 v29, v29
    v_exp_f32 v30, v30
    v_exp_f32 v31, v31
    v_pk_fma_f32 v[24:25], v[24:25], v[16:17], s[28:29] clamp
    v_pk_fma_f32 v[26:27], v[26:27], v[18:19], s[28:29] clamp
    v_pk_fma_f32 v[28:29], v[28:29], v[16:17], s[28:29] clamp
    v_pk_fma_f32 v[30:31], v[30:31], v[18:19], s[28:29] clamp
    v_pk_mul_f32 v[40:41], v[24:25], v[28:29]
    v_pk_mul_f32 v[42:43], v[26:27], v[30:31]
    v_rcp_f32 v40, v40
    v_rcp_f32 v41, v41
    v_rcp_f32 v42, v42
    v_rcp_f32 v43, v43
    v_pk_add_f32 v[48:49], v[24:25], v[28:29]
    v_pk_add_f32 v[50:51], v[26:27], v[30:31]
    v_pk_mul_f32 v[52:53], v[32:33], v[28:29]
    v_pk_mul_f32 v[54:55], v[34:35], v[30:31]
    v_pk_fma_f32 v[52:53], v[36:37], v[24:25], v[52:53]
    v_pk_fma_f32 v[54:55], v[38:39], v[26:27], v[54:55]
    v_pk_fma_f32 v[12:13], v[48:49], v[40:41], v[12:13]
    v_pk_fma_f32 v[14:15], v[50:51], v[42:43], v[14:15]
    v_pk_fma_f32 v[8:9], v[52:53], v[40:41], v[8:9]
    v_pk_fma_f32 v[10:11], v[54:55], v[42:43], v[10:11]
    s_bitcmp1_b64 s[34:35], 1
    s_cbranch_scc1 K_EV1
K_RT1:
    s_waitcnt vmcnt(2) lgkmcnt(0)
    v_pk_fma_f32 v[24:25], v[100:101], v[20:21], v[64:65] op_sel_hi:[0,1,1]
    v_pk_fma_f32 v[26:27], v[100:101], v[22:23], v[66:67] op_sel_hi:[0,1,1]
    v_pk_fma_f32 v[28:29], v[100:101], v[20:21], v[68:69] op_sel:[1,0,0] op_sel_hi:[1,1,1]
    v_pk_fma_f32 v[30:31], v[100:101], v[22:23], v[70:71] op_sel:[1,0,0] op_sel_hi:[1,1,1]
    v_lshlrev_b64 v[32:33], 16, v[64:65]
    v_lshlrev_b64 v[34:35], 16, v[66:67]
    v_lshlrev_b64 v[36:37], 16, v[68:69]
    v_lshlrev_b64 v[38:39], 16, v[70:71]
    buffer_load_dwordx4 v[64:67], v[44:45], s[8:11], 0 idxen offen sc1
    buffer_load_dwordx4 v[68:71], v[46:47], s[8:11], 0 idxen offen sc1
    ds_read_u16 v44, v2 offset:16
    ds_read_u16 v46, v2 offset:20
    ds_read_u16_d16_hi v100, v2 offset:18
    ds_read_u16_d16_hi v101, v2 offset:22
    v_exp_f32 v24, v24
    v_exp_f32 v25, v25
    v_exp_f32 v26, v26
    v_exp_f32 v27, v27
    v_exp_f32 v28, v28
    v_exp_f32 v29, v29
    v_exp_f32 v30, v30
    v_exp_f32 v31, v31
    v_pk_fma_f32 v[24:25], v[24:25], v[16:17], s[28:29] clamp
    v_pk_fma_f32 v[26:27], v[26:27], v[18:19], s[28:29] clamp
    v_pk_fma_f32 v[28:29], v[28:29], v[16:17], s[28:29] clamp
    v_pk_fma_f32 v[30:31], v[30:31], v[18:19], s[28:29] clamp
    v_pk_mul_f32 v[40:41], v[24:25], v[28:29]
    v_pk_mul_f32 v[42:43], v[26:27], v[30:31]
    v_rcp_f32 v40, v40
    v_rcp_f32 v41, v41
    v_rcp_f32 v42, v42
    v_rcp_f32 v43, v43
    v_pk_add_f32 v[48:49], v[24:25], v[28:29]
    v_pk_add_f32 v[50:51], v[26:27], v[30:31]
    v_pk_mul_f32 v[52:53], v[32:33], v[28:29]
    v_pk_mul_f32 v[54:55], v[34:35], v[30:31]
    v_pk_fma_f32 v[52:53], v[36:37], v[24:25], v[52:53]
    v_pk_fma_f32 v[54:55], v[38:39], v[26:27], v[54:55]
    v_pk_fma_f32 v[12:13], v[48:49], v[40:41], v[12:13]
    v_pk_fma_f32 v[14:15], v[50:51], v[42:43], v[14:15]
    v_pk_fma_f32 v[8:9], v[52:53], v[40:41], v[8:9]
    v_pk_fma_f32 v[10:11], v[54:55], v[42:43], v[10:11]
    s_bitcmp1_b64 s[34:35], 2
    s_cbranch_scc1 K_EV2
K_RT2:
    s_waitcnt vmcnt(2) lgkmcnt(0)
    v_pk_fma_f32 v[24:25], v[96:97], v[20:21], v[72:73] op_sel_hi:[0,1,1]
    v_pk_fma_f32 v[26:27], v[96:97], v[22:23], v[74:75] op_sel_hi:[0,1,1]
    v_pk_fma_f32 v[28:29], v[96:97], v[20:21], v[76:77] op_sel:[1,0,0] op_sel_hi:[1,1,1]
    v_pk_fma_f32 v[30:31], v[96:97], v[22:23], v[78:79] op_sel:[1,0,0] op_sel_hi:[1,1,1]
    v_lshlrev_b64 v[32:33], 16, v[72:73]
    v_lshlrev_b64 v[34:35], 16, v[74:75]
    v_lshlrev_b64 v[36:37], 16, v[76:77]
    v_lshlrev_b64 v[38:39], 16, v[78:79]
    buffer_load_dwordx4 v[72:75], v[44:45], s[8:11], 0 idxen offen sc1
    buffer_load_dwordx4 v[76:79], v[46:47], s[8:11], 0 idxen offen sc1
    ds_read_u16 v44, v2 offset:24
    ds_read_u16 v46, v2 offset:28
    ds_read_u16_d16_hi v96, v2 offset:26
    ds_read_u16_d16_hi v97, v2 offset:30
    v_exp_f32 v24, v24
    v_exp_f32 v25, v25
    v_exp_f32 v26, v26
    v_exp_f32 v27, v27
    v_exp_f32 v28, v28
    v_exp_f32 v29, v29
    v_exp_f32 v30, v30
    v_exp_f32 v31, v31
    v_pk_fma_f32 v[24:25], v[24:25], v[16:17], s[28:29] clamp
    v_pk_fma_f32 v[26:27], v[26:27], v[18:19], s[28:29] clamp
    v_pk_fma_f32 v[28:29], v[28:29], v[16:17], s[28:29] clamp
    v_pk_fma_f32 v[30:31], v[30:31], v[18:19], s[28:29] clamp
    v_pk_mul_f32 v[40:41], v[24:25], v[28:29]
    v_pk_mul_f32 v[42:43], v[26:27], v[30:31]
    v_rcp_f32 v40, v40
    v_rcp_f32 v41, v41
    v_rcp_f32 v42, v42
    v_rcp_f32 v43, v43
    v_pk_add_f32 v[48:49], v[24:25], v[28:29]
    v_pk_add_f32 v[50:51], v[26:27], v[30:31]
    v_pk_mul_f32 v[52:53], v[32:33], v[28:29]
    v_pk_mul_f32 v[54:55], v[34:35], v[30:31]
    v_pk_fma_f32 v[52:53], v[36:37], v[24:25], v[52:53]
    v_pk_fma_f32 v[54:55], v[38:39], v[26:27], v[54:55]
    v_pk_fma_f32 v[12:13], v[48:49], v[40:41], v[12:13]
    v_pk_fma_f32 v[14:15], v[50:51], v[42:43], v[14:15]
    v_pk_fma_f32 v[8:9], v[52:53], v[40:41], v[8:9]
    v_pk_fma_f32 v[10:11], v[54:55], v[42:43], v[10:11]
    s_bitcmp1_b64 s[34:35], 3
    s_cbranch_scc1 K_EV3
K_RT3:
    s_waitcnt vmcnt(2) lgkmcnt(0)
    v_pk_fma_f32 v[24:25], v[98:99], v[20:21], v[64:65] op_sel_hi:[0,1,1]
    v_pk_fma_f32 v[26:27], v[98:99], v[22:23], v[66:67] op_sel_hi:[0,1,1]
    v_pk_fma_f32 v[28:29], v[98:99], v[20:21], v[68:69] op_sel:[1,0,0] op_sel_hi:[1,1,1]
    v_pk_fma_f32 v[30:31], v[98:99], v[22:23], v[70:71] op_sel:[1,0,0] op_sel_hi:[1,1,1]
    v_lshlrev_b64 v[32:33], 16, v[64:65]
    v_lshlrev_b64 v[34:35], 16, v[66:67]
    v_lshlrev_b64 v[36:37], 16, v[68:69]
    v_lshlrev_b64 v[38:39], 16, v[70:71]
    buffer_load_dwordx4 v[64:67], v[44:45], s[8:11], 0 idxen offen sc1
    buffer_load_dwordx4 v[68:71], v[46:47], s[8:11], 0 idxen offen sc1
    ds_read_u16 v44, v2 offset:32
    ds_read_u16 v46, v2 offset:36
    ds_read_u16_d16_hi v98, v2 offset:34
    ds_read_u16_d16_hi v99, v2 offset:38
    v_exp_f32 v24, v24
    v_exp_f32 v25, v25
    v_exp_f32 v26, v26
    v_exp_f32 v27, v27
    v_exp_f32 v28, v28
    v_exp_f32 v29, v29
    v_exp_f32 v30, v30
    v_exp_f32 v31, v31
    v_pk_fma_f32 v[24:25], v[24:25], v[16:17], s[28:29] clamp
    v_pk_fma_f32 v[26:27], v[26:27], v[18:19], s[28:29] clamp
    v_pk_fma_f32 v[28:29], v[28:29], v[16:17], s[28:29] clamp
    v_pk_fma_f32 v[30:31], v[30:31], v[18:19], s[28:29] clamp
    v_pk_mul_f32 v[40:41], v[24:25], v[28:29]
    v_pk_mul_f32 v[42:43], v[26:27], v[30:31]
    v_rcp_f32 v40, v40
    v_rcp_f32 v41, v41
    v_rcp_f32 v42, v42
    v_rcp_f32 v43, v43
    v_pk_add_f32 v[48:49], v[24:25], v[28:29]
    v_pk_add_f32 v[50:51], v[26:27], v[30:31]
    v_pk_mul_f32 v[52:53], v[32:33], v[28:29]
    v_pk_mul_f32 v[54:55], v[34:35], v[30:31]
    v_pk_fma_f32 v[52:53], v[36:37], v[24:25], v[52:53]
    v_pk_fma_f32 v[54:55], v[38:39], v[26:27], v[54:55]
    v_pk_fma_f32 v[12:13], v[48:49], v[40:41], v[12:13]
    v_pk_fma_f32 v[14:15], v[50:51], v[42:43], v[14:15]
    v_pk_fma_f32 v[8:9], v[52:53], v[40:41], v[8:9]
    v_pk_fma_f32 v[10:11], v[54:55], v[42:43], v[10:11]
    s_bitcmp1_b64 s[34:35], 4
    s_cbranch_scc1 K_EV4
K_RT4:
    s_waitcnt vmcnt(2) lgkmcnt(0)
    v_pk_fma_f32 v[24:25], v[100:101], v[20:21], v[72:73] op_sel_hi:[0,1,1]
    v_pk_fma_f32 v[26:27], v[100:101], v[22:23], v[74:75] op_sel_hi:[0,1,1]
    v_pk_fma_f32 v[28:29], v[100:101], v[20:21], v[76:77] op_sel:[1,0,0] op_sel_hi:[1,1,1]
    v_pk_fma_f32 v[30:31], v[100:101], v[22:23], v[78:79] op_sel:[1,0,0] op_sel_hi:[1,1,1]
    v_lshlrev_b64 v[32:33], 16, v[72:73]
    v_lshlrev_b64 v[34:35], 16, v[74:75]
    v_lshlrev_b64 v[36:37], 16, v[76:77]
    v_lshlrev_b64 v[38:39], 16, v[78:79]
    buffer_load_dwordx4 v[72:75], v[44:45], s[8:11], 0 idxen offen sc1
    buffer_load_dwordx4 v[76:79], v[46:47], s[8:11], 0 idxen offen sc1
    ds_read_u16 v44, v2 offset:40
    ds_read_u16 v46, v2 offset:44
    ds_read_u16_d16_hi v100, v2 offset:42
    ds_read_u16_d16_hi v101, v2 offset:46
    v_exp_f32 v24, v24
    v_exp_f32 v25, v25
    v_exp_f32 v26, v26
    v_exp_f32 v27, v27
    v_exp_f32 v28, v28
    v_exp_f32 v29, v29
    v_exp_f32 v30, v30
    v_exp_f32 v31, v31
    v_pk_fma_f32 v[24:25], v[24:25], v[16:17], s[28:29] clamp
    v_pk_fma_f32 v[26:27], v[26:27], v[18:19], s[28:29] clamp
    v_pk_fma_f32 v[28:29], v[28:29], v[16:17], s[28:29] clamp
    v_pk_fma_f32 v[30:31], v[30:31], v[18:19], s[28:29] clamp
    v_pk_mul_f32 v[40:41], v[24:25], v[28:29]
    v_pk_mul_f32 v[42:43], v[26:27], v[30:31]
    v_rcp_f32 v40, v40
    v_rcp_f32 v41, v41
    v_rcp_f32 v42, v42
    v_rcp_f32 v43, v43
    v_pk_add_f32 v[48:49], v[24:25], v[28:29]
    v_pk_add_f32 v[50:51], v[26:27], v[30:31]
    v_pk_mul_f32 v[52:53], v[32:33], v[28:29]
    v_pk_mul_f32 v[54:55], v[34:35], v[30:31]
    v_pk_fma_f32 v[52:53], v[36:37], v[24:25], v[52:53]
    v_pk_fma_f32 v[54:55], v[38:39], v[26:27], v[54:55]
    v_pk_fma_f32 v[12:13], v[48:49], v[40:41], v[12:13]
    v_pk_fma_f32 v[14:15], v[50:51], v[42:43], v[14:15]
    v_pk_fma_f32 v[8:9], v[52:53], v[40:41], v[8:9]
    v_pk_fma_f32 v[10:11], v[54:55], v[42:43], v[10:11]
    s_bitcmp1_b64 s[34:35], 5
    s_cbranch_scc1 K_EV5
K_RT5:
    v_add_u32 v2, 48, v2
    s_lshr_b64 s[34:35], s[34:35], 6
    s_cbranch_scc1 K_LOOP
    s_branch K_TAIL
K_EV0:
    s_mov_b32 s46, 0
    s_call_b64 s[50:51], K_EVENT
    s_branch K_RT0
K_EV1:
    s_mov_b32 s46, 1
    s_call_b64 s[50:51], K_EVENT
    s_branch K_RT1
K_EV2:
    s_mov_b32 s46, 2
    s_call_b64 s[50:51], K_EVENT
    s_branch K_RT2
K_EV3:
    s_mov_b32 s46, 3
    s_call_b64 s[50:51], K_EVENT
    s_branch K_RT3
K_EV4:
    s_mov_b32 s46, 4
    s_call_b64 s[50:51], K_EVENT
    s_branch K_RT4
K_EV5:
    s_mov_b32 s46, 5
    s_call_b64 s[50:51], K_EVENT
    s_branch K_RT5
K_FETCH:
    s_add_u32 s44, s44, 1
    s_lshl_b32 s60, s46, 3
    s_sub_u32 s60, 95864, s60
    v_mov_b32 v62, s60
    s_movk_i32 s61, 296
    v_mad_u32_u24 v2, v3, s61, v62
    s_sub_u32 s60, s44, s43
    s_lshl_b32 s60, s60, 5
    v_add_u32 v62, s60, v4
    ds_read_b32 v3, v62 offset:1568
    s_setpc_b64 s[52:53]
K_EVENT:
    s_ff1_i32_b64 s64, s[36:37]
    s_bitset0_b64 s[36:37], s64
    s_bitcmp1_b64 s[40:41], s64
    s_cbranch_scc0 K_E1
    s_call_b64 s[52:53], K_FETCH
K_E1:
    s_bitcmp1_b64 s[38:39], s64
    s_cbranch_scc0 K_E3
    s_cmp_eq_u32 s45, 1
    s_cbranch_scc0 K_E2
    s_mov_b32 s45, 0
    s_mov_b32 s62, 1
    s_call_b64 s[52:53], K_PART
    s_branch K_E2B
K_E2:
    v_pk_add_f32 v[12:13], v[12:13], s[54:55]
    v_pk_add_f32 v[14:15], v[14:15], s[54:55]
    v_rcp_f32 v12, v12
    v_rcp_f32 v13, v13
    v_rcp_f32 v14, v14
    v_rcp_f32 v15, v15
    v_and_b32 v24, s49, v56
    v_and_b32 v25, s49, v57
    v_and_b32 v26, s49, v58
    v_and_b32 v27, s49, v59
    v_lshlrev_b32 v32, 16, v56
    v_lshlrev_b32 v33, 16, v57
    v_lshlrev_b32 v34, 16, v58
    v_lshlrev_b32 v35, 16, v59
    v_pk_fma_f32 v[24:25], v[8:9], v[12:13], v[24:25]
    v_pk_fma_f32 v[26:27], v[10:11], v[14:15], v[26:27]
    v_lshl_add_u32 v28, v7, 7, v6
    v_cmp_gt_u32 vcc, 196, v7
    v_max_f32 v24, 0, v24
    v_max_f32 v25, 0, v25
    v_max_f32 v26, 0, v26
    v_max_f32 v27, 0, v27
    v_pk_add_f32 v[24:25], v[24:25], v[32:33]
    v_pk_add_f32 v[26:27], v[26:27], v[34:35]
    v_cndmask_b32 v28, -1, v28, vcc
    v_cvt_pk_bf16_f32 v30, v24, v25
    v_cvt_pk_bf16_f32 v31, v26, v27
    buffer_store_dwordx2 v[30:31], v28, s[12:15], 0 offen sc1
K_E2B:
    s_cmp_eq_u32 s64, s42
    s_cbranch_scc1 K_DONE
    s_add_u32 s43, s43, 1
    v_add_u32 v4, 32, v4
    v_mov_b32 v7, v60
    ds_read_b32 v60, v4 offset:1568
    s_movk_i32 s61, 272
    v_mad_u32_u24 v62, v7, s61, v5
    ds_read_b128 v[56:59], v62 offset:128
    v_exp_f32 v16, v116
    v_exp_f32 v17, v117
    v_exp_f32 v18, v118
    v_exp_f32 v19, v119
    v_mov_b32 v8, 0
    v_mov_b32 v9, 0
    v_mov_b32 v10, 0
    v_mov_b32 v11, 0
    v_mov_b32 v12, 0
    v_mov_b32 v13, 0
    v_mov_b32 v14, 0
    v_mov_b32 v15, 0
    s_waitcnt lgkmcnt(1)
    v_mad_u32_u24 v62, v60, s61, v5
    ds_read_b128 v[116:119], v62
K_E3:
    s_sub_u32 s60, s42, s64
    s_cmp_eq_u32 s60, 0
    s_cbranch_scc1 K_TAIL
    s_cmp_gt_u32 s60, 7
    s_cbranch_scc1 K_E4
    s_setprio 2
    s_cmp_gt_u32 s60, 4
    s_cbranch_scc1 K_E4
    s_setprio 1
    s_cmp_gt_u32 s60, 2
    s_cbranch_scc1 K_E4
    s_setprio 0
K_E4:
    s_setpc_b64 s[50:51]
K_PART:
    s_lshl_b32 s60, s33, 11
    s_add_u32 s60, s60, 62080
    v_lshl_add_u32 v62, v1, 4, s60
    ds_write_b128 v62, v[8:11]
    ds_write_b128 v62, v[12:15] offset:1024
    s_lshl_b32 s60, s33, 2
    v_mov_b32 v62, s60
    v_mov_b32 v63, s62
    ds_write_b32 v62, v63 offset:1472
    s_setpc_b64 s[52:53]
K_TAIL:
    s_cmp_eq_u32 s45, 1
    s_cbranch_scc0 K_TL
    s_mov_b32 s62, 2
    s_call_b64 s[52:53], K_PART
    s_branch K_DONE
K_TL:
    s_add_u32 s33, s33, 1
    s_cmp_ge_u32 s33, 16
    s_cbranch_scc1 K_TF
    s_lshl_b32 s60, s33, 2
    v_mov_b32 v63, s60
    s_lshl_b32 s60, s33, 11
    s_add_u32 s60, s60, 62080
    v_lshl_add_u32 v62, v1, 4, s60
    s_mov_b32 s61, 0x100000
K_TW:
    s_sub_u32 s61, s61, 1
    s_cbranch_scc1 K_TF
    ds_read_b32 v61, v63 offset:1472
    ds_read_b128 v[104:107], v62
    ds_read_b128 v[108:111], v62 offset:1024
    s_waitcnt lgkmcnt(0)
    v_readfirstlane_b32 s60, v61
    s_cmp_eq_u32 s60, 0
    s_cbranch_scc1 K_TW
    v_pk_add_f32 v[8:9], v[8:9], v[104:105]
    v_pk_add_f32 v[10:11], v[10:11], v[106:107]
    v_pk_add_f32 v[12:13], v[12:13], v[108:109]
    v_pk_add_f32 v[14:15], v[14:15], v[110:111]
    s_cmp_eq_u32 s60, 2
    s_cbranch_scc1 K_TL
K_TF:
    v_pk_add_f32 v[12:13], v[12:13], s[54:55]
    v_pk_add_f32 v[14:15], v[14:15], s[54:55]
    v_rcp_f32 v12, v12
    v_rcp_f32 v13, v13
    v_rcp_f32 v14, v14
    v_rcp_f32 v15, v15
    v_and_b32 v24, s49, v56
    v_and_b32 v25, s49, v57
    v_and_b32 v26, s49, v58
    v_and_b32 v27, s49, v59
    v_lshlrev_b32 v32, 16, v56
    v_lshlrev_b32 v33, 16, v57
    v_lshlrev_b32 v34, 16, v58
    v_lshlrev_b32 v35, 16, v59
    v_pk_fma_f32 v[24:25], v[8:9], v[12:13], v[24:25]
    v_pk_fma_f32 v[26:27], v[10:11], v[14:15], v[26:27]
    v_lshl_add_u32 v28, v7, 7, v6
    v_cmp_gt_u32 vcc, 196, v7
    v_max_f32 v24, 0, v24
    v_max_f32 v25, 0, v25
    v_max_f32 v26, 0, v26
    v_max_f32 v27, 0, v27
    v_pk_add_f32 v[24:25], v[24:25], v[32:33]
    v_pk_add_f32 v[26:27], v[26:27], v[34:35]
    v_cndmask_b32 v28, -1, v28, vcc
    v_cvt_pk_bf16_f32 v30, v24, v25
    v_cvt_pk_bf16_f32 v31, v26, v27
    buffer_store_dwordx2 v[30:31], v28, s[12:15], 0 offen sc1
K_DONE:
K_FIN:
K_END:
    s_endpgm
K_SLOW:
    s_setprio 0
    s_waitcnt vmcnt(0)
    v_mov_b32 v36, 0
    v_mov_b32 v37, 0
    v_mov_b32 v38, 0
    v_mov_b32 v39, 0
    v_lshlrev_b32 v29, 4, v0
    v_add_u32 v29, 95872, v29
    ds_write_b128 v29, v[36:39]
    ds_write_b128 v29, v[36:39] offset:16384
    ds_write_b128 v29, v[36:39] offset:32768
    ds_write_b128 v29, v[36:39] offset:49152
    v_and_b32 v28, 31, v1
    v_lshlrev_b32 v30, 1, v28
    s_lshl_b32 s60, s31, 6
    s_mov_b32 s20, s86
    s_mov_b32 s21, s87
    s_mov_b32 s22, 8192
    s_mov_b32 s23, 0x20000
    s_mov_b32 s24, s92
    s_mov_b32 s25, s93
    s_mov_b32 s26, 8192
    s_mov_b32 s27, 0x20000
    s_mov_b32 s61, s60
    s_mov_b32 exec_hi, 0
    buffer_load_ushort v32, v30, s[20:23], s61 offen
    buffer_load_ushort v33, v30, s[20:23], s61 offen offset:128
    s_not_b64 exec, exec
    buffer_load_ushort v32, v30, s[24:27], s61 offen
    buffer_load_ushort v33, v30, s[24:27], s61 offen offset:128
    s_mov_b64 exec, -1
    s_add_u32 s61, s61, 256
    s_waitcnt vmcnt(0)
    v_lshl_or_b32 v64, v33, 16, v32
    s_mov_b32 exec_hi, 0
    buffer_load_ushort v32, v30, s[20:23], s61 offen
    buffer_load_ushort v33, v30, s[20:23], s61 offen offset:128
    s_not_b64 exec, exec
    buffer_load_ushort v32, v30, s[24:27], s61 offen
    buffer_load_ushort v33, v30, s[24:27], s61 offen offset:128
    s_mov_b64 exec, -1
    s_add_u32 s61, s61, 256
    s_waitcnt vmcnt(0)
    v_lshl_or_b32 v65, v33, 16, v32
    s_mov_b32 exec_hi, 0
    buffer_load_ushort v32, v30, s[20:23], s61 offen
    buffer_load_ushort v33, v30, s[20:23], s61 offen offset:128
    s_not_b64 exec, exec
    buffer_load_ushort v32, v30, s[24:27], s61 offen
    buffer_load_ushort v33, v30, s[24:27], s61 offen offset:128
    s_mov_b64 exec, -1
    s_add_u32 s61, s61, 256
    s_waitcnt vmcnt(0)
    v_lshl_or_b32 v66, v33, 16, v32
    s_mov_b32 exec_hi, 0
    buffer_load_ushort v32, v30, s[20:23], s61 offen
    buffer_load_ushort v33, v30, s[20:23], s61 offen offset:128
    s_not_b64 exec, exec
    buffer_load_ushort v32, v30, s[24:27], s61 offen
    buffer_load_ushort v33, v30, s[24:27], s61 offen offset:128
    s_mov_b64 exec, -1
    s_add_u32 s61, s61, 256
    s_waitcnt vmcnt(0)
    v_lshl_or_b32 v67, v33, 16, v32
    s_mov_b32 exec_hi, 0
    buffer_load_ushort v32, v30, s[20:23], s61 offen
    buffer_load_ushort v33, v30, s[20:23], s61 offen offset:128
    s_not_b64 exec, exec
    buffer_load_ushort v32, v30, s[24:27], s61 offen
    buffer_load_ushort v33, v30, s[24:27], s61 offen offset:128
    s_mov_b64 exec, -1
    s_add_u32 s61, s61, 256
    s_waitcnt vmcnt(0)
    v_lshl_or_b32 v68, v33, 16, v32
    s_mov_b32 exec_hi, 0
    buffer_load_ushort v32, v30, s[20:23], s61 offen
    buffer_load_ushort v33, v30, s[20:23], s61 offen offset:128
    s_not_b64 exec, exec
    buffer_load_ushort v32, v30, s[24:27], s61 offen
    buffer_load_ushort v33, v30, s[24:27], s61 offen offset:128
    s_mov_b64 exec, -1
    s_add_u32 s61, s61, 256
    s_waitcnt vmcnt(0)
    v_lshl_or_b32 v69, v33, 16, v32
    s_mov_b32 exec_hi, 0
    buffer_load_ushort v32, v30, s[20:23], s61 offen
    buffer_load_ushort v33, v30, s[20:23], s61 offen offset:128
    s_not_b64 exec, exec
    buffer_load_ushort v32, v30, s[24:27], s61 offen
    buffer_load_ushort v33, v30, s[24:27], s61 offen offset:128
    s_mov_b64 exec, -1
    s_add_u32 s61, s61, 256
    s_waitcnt vmcnt(0)
    v_lshl_or_b32 v70, v33, 16, v32
    s_mov_b32 exec_hi, 0
    buffer_load_ushort v32, v30, s[20:23], s61 offen
    buffer_load_ushort v33, v30, s[20:23], s61 offen offset:128
    s_not_b64 exec, exec
    buffer_load_ushort v32, v30, s[24:27], s61 offen
    buffer_load_ushort v33, v30, s[24:27], s61 offen offset:128
    s_mov_b64 exec, -1
    s_add_u32 s61, s61, 256
    s_waitcnt vmcnt(0)
    v_lshl_or_b32 v71, v33, 16, v32
    s_mov_b32 exec_hi, 0
    buffer_load_ushort v32, v30, s[20:23], s61 offen
    buffer_load_ushort v33, v30, s[20:23], s61 offen offset:128
    s_not_b64 exec, exec
    buffer_load_ushort v32, v30, s[24:27], s61 offen
    buffer_load_ushort v33, v30, s[24:27], s61 offen offset:128
    s_mov_b64 exec, -1
    s_add_u32 s61, s61, 256
    s_waitcnt vmcnt(0)
    v_lshl_or_b32 v72, v33, 16, v32
    s_mov_b32 exec_hi, 0
    buffer_load_ushort v32, v30, s[20:23], s61 offen
    buffer_load_ushort v33, v30, s[20:23], s61 offen offset:128
    s_not_b64 exec, exec
    buffer_load_ushort v32, v30, s[24:27], s61 offen
    buffer_load_ushort v33, v30, s[24:27], s61 offen offset:128
    s_mov_b64 exec, -1
    s_add_u32 s61, s61, 256
    s_waitcnt vmcnt(0)
    v_lshl_or_b32 v73, v33, 16, v32
    s_mov_b32 exec_hi, 0
    buffer_load_ushort v32, v30, s[20:23], s61 offen
    buffer_load_ushort v33, v30, s[20:23], s61 offen offset:128
    s_not_b64 exec, exec
    buffer_load_ushort v32, v30, s[24:27], s61 offen
    buffer_load_ushort v33, v30, s[24:27], s61 offen offset:128
    s_mov_b64 exec, -1
    s_add_u32 s61, s61, 256
    s_waitcnt vmcnt(0)
    v_lshl_or_b32 v74, v33, 16, v32
    s_mov_b32 exec_hi, 0
    buffer_load_ushort v32, v30, s[20:23], s61 offen
    buffer_load_ushort v33, v30, s[20:23], s61 offen offset:128
    s_not_b64 exec, exec
    buffer_load_ushort v32, v30, s[24:27], s61 offen
    buffer_load_ushort v33, v30, s[24:27], s61 offen offset:128
    s_mov_b64 exec, -1
    s_add_u32 s61, s61, 256
    s_waitcnt vmcnt(0)
    v_lshl_or_b32 v75, v33, 16, v32
    s_mov_b32 exec_hi, 0
    buffer_load_ushort v32, v30, s[20:23], s61 offen
    buffer_load_ushort v33, v30, s[20:23], s61 offen offset:128
    s_not_b64 exec, exec
    buffer_load_ushort v32, v30, s[24:27], s61 offen
    buffer_load_ushort v33, v30, s[24:27], s61 offen offset:128
    s_mov_b64 exec, -1
    s_add_u32 s61, s61, 256
    s_waitcnt vmcnt(0)
    v_lshl_or_b32 v76, v33, 16, v32
    s_mov_b32 exec_hi, 0
    buffer_load_ushort v32, v30, s[20:23], s61 offen
    buffer_load_ushort v33, v30, s[20:23], s61 offen offset:128
    s_not_b64 exec, exec
    buffer_load_ushort v32, v30, s[24:27], s61 offen
    buffer_load_ushort v33, v30, s[24:27], s61 offen offset:128
    s_mov_b64 exec, -1
    s_add_u32 s61, s61, 256
    s_waitcnt vmcnt(0)
    v_lshl_or_b32 v77, v33, 16, v32
    s_mov_b32 exec_hi, 0
    buffer_load_ushort v32, v30, s[20:23], s61 offen
    buffer_load_ushort v33, v30, s[20:23], s61 offen offset:128
    s_not_b64 exec, exec
    buffer_load_ushort v32, v30, s[24:27], s61 offen
    buffer_load_ushort v33, v30, s[24:27], s61 offen offset:128
    s_mov_b64 exec, -1
    s_add_u32 s61, s61, 256
    s_waitcnt vmcnt(0)
    v_lshl_or_b32 v78, v33, 16, v32
    s_mov_b32 exec_hi, 0
    buffer_load_ushort v32, v30, s[20:23], s61 offen
    buffer_load_ushort v33, v30, s[20:23], s61 offen offset:128
    s_not_b64 exec, exec
    buffer_load_ushort v32, v30, s[24:27], s61 offen
    buffer_load_ushort v33, v30, s[24:27], s61 offen offset:128
    s_mov_b64 exec, -1
    s_add_u32 s61, s61, 256
    s_waitcnt vmcnt(0)
    v_lshl_or_b32 v79, v33, 16, v32
    s_mov_b32 exec_hi, 0
    buffer_load_ushort v32, v30, s[20:23], s61 offen
    buffer_load_ushort v33, v30, s[20:23], s61 offen offset:128
    s_not_b64 exec, exec
    buffer_load_ushort v32, v30, s[24:27], s61 offen
    buffer_load_ushort v33, v30, s[24:27], s61 offen offset:128
    s_mov_b64 exec, -1
    s_add_u32 s61, s61, 256
    s_waitcnt vmcnt(0)
    v_lshl_or_b32 v80, v33, 16, v32
    s_mov_b32 exec_hi, 0
    buffer_load_ushort v32, v30, s[20:23], s61 offen
    buffer_load_ushort v33, v30, s[20:23], s61 offen offset:128
    s_not_b64 exec, exec
    buffer_load_ushort v32, v30, s[24:27], s61 offen
    buffer_load_ushort v33, v30, s[24:27], s61 offen offset:128
    s_mov_b64 exec, -1
    s_add_u32 s61, s61, 256
    s_waitcnt vmcnt(0)
    v_lshl_or_b32 v81, v33, 16, v32
    s_mov_b32 exec_hi, 0
    buffer_load_ushort v32, v30, s[20:23], s61 offen
    buffer_load_ushort v33, v30, s[20:23], s61 offen offset:128
    s_not_b64 exec, exec
    buffer_load_ushort v32, v30, s[24:27], s61 offen
    buffer_load_ushort v33, v30, s[24:27], s61 offen offset:128
    s_mov_b64 exec, -1
    s_add_u32 s61, s61, 256
    s_waitcnt vmcnt(0)
    v_lshl_or_b32 v82, v33, 16, v32
    s_mov_b32 exec_hi, 0
    buffer_load_ushort v32, v30, s[20:23], s61 offen
    buffer_load_ushort v33, v30, s[20:23], s61 offen offset:128
    s_not_b64 exec, exec
    buffer_load_ushort v32, v30, s[24:27], s61 offen
    buffer_load_ushort v33, v30, s[24:27], s61 offen offset:128
    s_mov_b64 exec, -1
    s_add_u32 s61, s61, 256
    s_waitcnt vmcnt(0)
    v_lshl_or_b32 v83, v33, 16, v32
    s_mov_b32 exec_hi, 0
    buffer_load_ushort v32, v30, s[20:23], s61 offen
    buffer_load_ushort v33, v30, s[20:23], s61 offen offset:128
    s_not_b64 exec, exec
    buffer_load_ushort v32, v30, s[24:27], s61 offen
    buffer_load_ushort v33, v30, s[24:27], s61 offen offset:128
    s_mov_b64 exec, -1
    s_add_u32 s61, s61, 256
    s_waitcnt vmcnt(0)
    v_lshl_or_b32 v84, v33, 16, v32
    s_mov_b32 exec_hi, 0
    buffer_load_ushort v32, v30, s[20:23], s61 offen
    buffer_load_ushort v33, v30, s[20:23], s61 offen offset:128
    s_not_b64 exec, exec
    buffer_load_ushort v32, v30, s[24:27], s61 offen
    buffer_load_ushort v33, v30, s[24:27], s61 offen offset:128
    s_mov_b64 exec, -1
    s_add_u32 s61, s61, 256
    s_waitcnt vmcnt(0)
    v_lshl_or_b32 v85, v33, 16, v32
    s_mov_b32 exec_hi, 0
    buffer_load_ushort v32, v30, s[20:23], s61 offen
    buffer_load_ushort v33, v30, s[20:23], s61 offen offset:128
    s_not_b64 exec, exec
    buffer_load_ushort v32, v30, s[24:27], s61 offen
    buffer_load_ushort v33, v30, s[24:27], s61 offen offset:128
    s_mov_b64 exec, -1
    s_add_u32 s61, s61, 256
    s_waitcnt vmcnt(0)
    v_lshl_or_b32 v86, v33, 16, v32
    s_mov_b32 exec_hi, 0
    buffer_load_ushort v32, v30, s[20:23], s61 offen
    buffer_load_ushort v33, v30, s[20:23], s61 offen offset:128
    s_not_b64 exec, exec
    buffer_load_ushort v32, v30, s[24:27], s61 offen
    buffer_load_ushort v33, v30, s[24:27], s61 offen offset:128
    s_mov_b64 exec, -1
    s_add_u32 s61, s61, 256
    s_waitcnt vmcnt(0)
    v_lshl_or_b32 v87, v33, 16, v32
    s_mov_b32 exec_hi, 0
    buffer_load_ushort v32, v30, s[20:23], s61 offen
    buffer_load_ushort v33, v30, s[20:23], s61 offen offset:128
    s_not_b64 exec, exec
    buffer_load_ushort v32, v30, s[24:27], s61 offen
    buffer_load_ushort v33, v30, s[24:27], s61 offen offset:128
    s_mov_b64 exec, -1
    s_add_u32 s61, s61, 256
    s_waitcnt vmcnt(0)
    v_lshl_or_b32 v88, v33, 16, v32
    s_mov_b32 exec_hi, 0
    buffer_load_ushort v32, v30, s[20:23], s61 offen
    buffer_load_ushort v33, v30, s[20:23], s61 offen offset:128
    s_not_b64 exec, exec
    buffer_load_ushort v32, v30, s[24:27], s61 offen
    buffer_load_ushort v33, v30, s[24:27], s61 offen offset:128
    s_mov_b64 exec, -1
    s_add_u32 s61, s61, 256
    s_waitcnt vmcnt(0)
    v_lshl_or_b32 v89, v33, 16, v32
    s_mov_b32 exec_hi, 0
    buffer_load_ushort v32, v30, s[20:23], s61 offen
    buffer_load_ushort v33, v30, s[20:23], s61 offen offset:128
    s_not_b64 exec, exec
    buffer_load_ushort v32, v30, s[24:27], s61 offen
    buffer_load_ushort v33, v30, s[24:27], s61 offen offset:128
    s_mov_b64 exec, -1
    s_add_u32 s61, s61, 256
    s_waitcnt vmcnt(0)
    v_lshl_or_b32 v90, v33, 16, v32
    s_mov_b32 exec_hi, 0
    buffer_load_ushort v32, v30, s[20:23], s61 offen
    buffer_load_ushort v33, v30, s[20:23], s61 offen offset:128
    s_not_b64 exec, exec
    buffer_load_ushort v32, v30, s[24:27], s61 offen
    buffer_load_ushort v33, v30, s[24:27], s61 offen offset:128
    s_mov_b64 exec, -1
    s_add_u32 s61, s61, 256
    s_waitcnt vmcnt(0)
    v_lshl_or_b32 v91, v33, 16, v32
    s_mov_b32 exec_hi, 0
    buffer_load_ushort v32, v30, s[20:23], s61 offen
    buffer_load_ushort v33, v30, s[20:23], s61 offen offset:128
    s_not_b64 exec, exec
    buffer_load_ushort v32, v30, s[24:27], s61 offen
    buffer_load_ushort v33, v30, s[24:27], s61 offen offset:128
    s_mov_b64 exec, -1
    s_add_u32 s61, s61, 256
    s_waitcnt vmcnt(0)
    v_lshl_or_b32 v92, v33, 16, v32
    s_mov_b32 exec_hi, 0
    buffer_load_ushort v32, v30, s[20:23], s61 offen
    buffer_load_ushort v33, v30, s[20:23], s61 offen offset:128
    s_not_b64 exec, exec
    buffer_load_ushort v32, v30, s[24:27], s61 offen
    buffer_load_ushort v33, v30, s[24:27], s61 offen offset:128
    s_mov_b64 exec, -1
    s_add_u32 s61, s61, 256
    s_waitcnt vmcnt(0)
    v_lshl_or_b32 v93, v33, 16, v32
    s_mov_b32 exec_hi, 0
    buffer_load_ushort v32, v30, s[20:23], s61 offen
    buffer_load_ushort v33, v30, s[20:23], s61 offen offset:128
    s_not_b64 exec, exec
    buffer_load_ushort v32, v30, s[24:27], s61 offen
    buffer_load_ushort v33, v30, s[24:27], s61 offen offset:128
    s_mov_b64 exec, -1
    s_add_u32 s61, s61, 256
    s_waitcnt vmcnt(0)
    v_lshl_or_b32 v94, v33, 16, v32
    s_mov_b32 exec_hi, 0
    buffer_load_ushort v32, v30, s[20:23], s61 offen
    buffer_load_ushort v33, v30, s[20:23], s61 offen offset:128
    s_not_b64 exec, exec
    buffer_load_ushort v32, v30, s[24:27], s61 offen
    buffer_load_ushort v33, v30, s[24:27], s61 offen offset:128
    s_mov_b64 exec, -1
    s_add_u32 s61, s61, 256
    s_waitcnt vmcnt(0)
    v_lshl_or_b32 v95, v33, 16, v32
    s_mov_b32 s20, s88
    s_mov_b32 s21, s89
    s_mov_b32 s22, 128
    s_mov_b32 s23, 0x20000
    buffer_load_ushort v34, v30, s[20:23], s60 offen
    v_lshlrev_b32 v30, 2, v28
    v_lshrrev_b32 v31, 5, v1
    v_xor_b32 v31, 1, v31
    v_lshl_add_u32 v35, v31, 7, v30
    v_add_u32 v35, 95872, v35
    v_add_u32 v30, 7680, v30
    v_lshlrev_b32 v31, 2, v28
    s_waitcnt vmcnt(0) lgkmcnt(0)
    v_lshlrev_b32 v34, 16, v34
    v_mul_f32 v34, 0xbfb8aa3b, v34
    s_mov_b32 s20, s82
    s_mov_b32 s21, s83
    s_mov_b32 s22, 3200000
    s_mov_b32 s23, 0x20000
    s_mov_b32 s24, s80
    s_mov_b32 s25, s81
    s_mov_b32 s26, 3200000
    s_mov_b32 s27, 0x20000
    s_mov_b32 s8, s78
    s_mov_b32 s9, s79
    s_mov_b32 s10, 1600000
    s_mov_b32 s11, 0x20000
    s_barrier
    v_mov_b32 v36, v0
    s_mov_b32 s56, 800000
K_SB:
    v_lshlrev_b32 v37, 2, v36
    v_lshlrev_b32 v38, 1, v36
    buffer_load_dword v39, v37, s[20:23], 0 offen
    buffer_load_dword v40, v37, s[24:27], 0 offen
    buffer_load_ushort v41, v38, s[8:11], 0 offen
    v_cmp_gt_u32 s[52:53], s56, v36
    s_waitcnt vmcnt(0)
    v_subrev_u32 v39, s59, v39
    v_cmp_gt_u32 vcc, 196, v39
    s_and_b64 s[52:53], s[52:53], vcc
K_SE:
    s_cmp_eq_u64 s[52:53], 0
    s_cbranch_scc1 K_SN
    s_ff1_i32_b64 s34, s[52:53]
    s_bitset0_b64 s[52:53], s34
    v_readlane_b32 s35, v40, s34
    v_readlane_b32 s57, v39, s34
    v_readlane_b32 s58, v41, s34
    s_min_u32 s35, s35, 24999
    s_lshl_b32 s35, s35, 7
    s_load_dwordx16 s[36:51], s[76:77], s35
    s_add_u32 s35, s35, 64
    s_load_dwordx16 s[60:75], s[76:77], s35
    s_mul_i32 s34, s57, 272
    v_add_u32 v42, s34, v30
    ds_read_b32 v43, v42
    s_lshl_b32 s58, s58, 16
    s_lshl_b32 s57, s57, 8
    v_mov_b32 v48, 0
    v_mov_b32 v49, 0
    s_waitcnt lgkmcnt(0)
    v_dot2_f32_bf16 v48, s36, v64, v48
    v_dot2_f32_bf16 v49, s60, v80, v49
    v_dot2_f32_bf16 v48, s37, v65, v48
    v_dot2_f32_bf16 v49, s61, v81, v49
    v_dot2_f32_bf16 v48, s38, v66, v48
    v_dot2_f32_bf16 v49, s62, v82, v49
    v_dot2_f32_bf16 v48, s39, v67, v48
    v_dot2_f32_bf16 v49, s63, v83, v49
    v_dot2_f32_bf16 v48, s40, v68, v48
    v_dot2_f32_bf16 v49, s64, v84, v49
    v_dot2_f32_bf16 v48, s41, v69, v48
    v_dot2_f32_bf16 v49, s65, v85, v49
    v_dot2_f32_bf16 v48, s42, v70, v48
    v_dot2_f32_bf16 v49, s66, v86, v49
    v_dot2_f32_bf16 v48, s43, v71, v48
    v_dot2_f32_bf16 v49, s67, v87, v49
    v_dot2_f32_bf16 v48, s44, v72, v48
    v_dot2_f32_bf16 v49, s68, v88, v49
    v_dot2_f32_bf16 v48, s45, v73, v48
    v_dot2_f32_bf16 v49, s69, v89, v49
    v_dot2_f32_bf16 v48, s46, v74, v48
    v_dot2_f32_bf16 v49, s70, v90, v49
    v_dot2_f32_bf16 v48, s47, v75, v48
    v_dot2_f32_bf16 v49, s71, v91, v49
    v_dot2_f32_bf16 v48, s48, v76, v48
    v_dot2_f32_bf16 v49, s72, v92, v49
    v_dot2_f32_bf16 v48, s49, v77, v48
    v_dot2_f32_bf16 v49, s73, v93, v49
    v_dot2_f32_bf16 v48, s50, v78, v48
    v_dot2_f32_bf16 v49, s74, v94, v49
    v_dot2_f32_bf16 v48, s51, v79, v48
    v_dot2_f32_bf16 v49, s75, v95, v49
    s_nop 3
    v_add_f32 v48, v48, v49
    v_fma_f32 v43, s58, v34, v43
    v_mul_f32 v49, 0xbfb8aa3b, v48
    v_add_f32 v49, v49, v43
    v_exp_f32 v49, v49
    s_nop 0
    v_add_f32 v49, s28, v49
    v_rcp_f32 v49, v49
    s_nop 1
    ds_bpermute_b32 v49, v31, v49
    v_cmp_gt_u32 vcc, 32, v1
    s_nop 1
    v_cndmask_b32 v48, v48, 1.0, vcc
    v_add_u32 v42, s57, v35
    s_waitcnt lgkmcnt(0)
    v_mul_f32 v49, v49, v48
    ds_add_f32 v42, v49
    s_branch K_SE
K_SN:
    v_add_u32 v36, 1024, v36
    s_nop 0
    v_readfirstlane_b32 s34, v36
    s_cmp_lt_u32 s34, 800000
    s_cbranch_scc1 K_SB
    s_mov_b32 s49, 0xffff0000
    s_movk_i32 s34, 272
    s_waitcnt lgkmcnt(0)
    s_barrier
    v_lshrrev_b32 v7, 3, v0
    v_add_u32 v63, 95872, v45
    v_min_u32 v36, 199, v7
    v_mad_u32_u24 v37, v36, s34, v5
    ds_read_b128 v[56:59], v37 offset:128
    v_lshl_add_u32 v39, v36, 8, v63
    ds_read_b128 v[8:11], v39
    ds_read_b128 v[12:15], v39 offset:128
    s_waitcnt lgkmcnt(0)
    v_pk_add_f32 v[12:13], v[12:13], s[54:55]
    v_pk_add_f32 v[14:15], v[14:15], s[54:55]
    v_rcp_f32 v12, v12
    v_rcp_f32 v13, v13
    v_rcp_f32 v14, v14
    v_rcp_f32 v15, v15
    v_and_b32 v24, s49, v56
    v_and_b32 v25, s49, v57
    v_and_b32 v26, s49, v58
    v_and_b32 v27, s49, v59
    v_lshlrev_b32 v32, 16, v56
    v_lshlrev_b32 v33, 16, v57
    v_lshlrev_b32 v34, 16, v58
    v_lshlrev_b32 v35, 16, v59
    v_pk_fma_f32 v[24:25], v[8:9], v[12:13], v[24:25]
    v_pk_fma_f32 v[26:27], v[10:11], v[14:15], v[26:27]
    v_lshl_add_u32 v28, v7, 7, v6
    v_cmp_gt_u32 vcc, 196, v7
    v_max_f32 v24, 0, v24
    v_max_f32 v25, 0, v25
    v_max_f32 v26, 0, v26
    v_max_f32 v27, 0, v27
    v_pk_add_f32 v[24:25], v[24:25], v[32:33]
    v_pk_add_f32 v[26:27], v[26:27], v[34:35]
    v_cndmask_b32 v28, -1, v28, vcc
    v_cvt_pk_bf16_f32 v30, v24, v25
    v_cvt_pk_bf16_f32 v31, v26, v27
    buffer_store_dwordx2 v[30:31], v28, s[12:15], 0 offen sc1
    v_add_u32 v7, 128, v7
    v_min_u32 v36, 199, v7
    v_mad_u32_u24 v37, v36, s34, v5
    ds_read_b128 v[56:59], v37 offset:128
    v_lshl_add_u32 v39, v36, 8, v63
    ds_read_b128 v[8:11], v39
    ds_read_b128 v[12:15], v39 offset:128
    s_waitcnt lgkmcnt(0)
    v_pk_add_f32 v[12:13], v[12:13], s[54:55]
    v_pk_add_f32 v[14:15], v[14:15], s[54:55]
    v_rcp_f32 v12, v12
    v_rcp_f32 v13, v13
    v_rcp_f32 v14, v14
    v_rcp_f32 v15, v15
    v_and_b32 v24, s49, v56
    v_and_b32 v25, s49, v57
    v_and_b32 v26, s49, v58
    v_and_b32 v27, s49, v59
    v_lshlrev_b32 v32, 16, v56
    v_lshlrev_b32 v33, 16, v57
    v_lshlrev_b32 v34, 16, v58
    v_lshlrev_b32 v35, 16, v59
    v_pk_fma_f32 v[24:25], v[8:9], v[12:13], v[24:25]
    v_pk_fma_f32 v[26:27], v[10:11], v[14:15], v[26:27]
    v_lshl_add_u32 v28, v7, 7, v6
    v_cmp_gt_u32 vcc, 196, v7
    v_max_f32 v24, 0, v24
    v_max_f32 v25, 0, v25
    v_max_f32 v26, 0, v26
    v_max_f32 v27, 0, v27
    v_pk_add_f32 v[24:25], v[24:25], v[32:33]
    v_pk_add_f32 v[26:27], v[26:27], v[34:35]
    v_cndmask_b32 v28, -1, v28, vcc
    v_cvt_pk_bf16_f32 v30, v24, v25
    v_cvt_pk_bf16_f32 v31, v26, v27
    buffer_store_dwordx2 v[30:31], v28, s[12:15], 0 offen sc1
    v_add_u32 v7, 128, v7
    s_endpgm
.section .rodata,"a"
.p2align 6
.amdhsa_kernel standalone__edge_featured_mpnn_gatedgcn__graph_kernel
  .amdhsa_next_free_vgpr 128
  .amdhsa_next_free_sgpr 102
  .amdhsa_accum_offset 128
  .amdhsa_group_segment_fixed_size 0
  .amdhsa_kernarg_size 96
  .amdhsa_user_sgpr_count 2
  .amdhsa_user_sgpr_kernarg_segment_ptr 1
  .amdhsa_system_sgpr_workgroup_id_x 1
  .amdhsa_float_denorm_mode_32 3
.end_amdhsa_kernel
```
